```python
import torch

def _softmax(x, axis=-1):
    return torch.softmax(x, dim=axis)
def _gelu(x):
    return torch.nn.functional.gelu(x, approximate="tanh")
def _silu(x):
    return torch.nn.functional.silu(x)
def _sigmoid(x):
    return torch.sigmoid(x)
def _layernorm(x, axis=-1, eps=1e-5):
    m = x.mean(dim=axis, keepdim=True)
    v = x.var(dim=axis, keepdim=True, unbiased=False)
    return (x - m) / torch.sqrt(v + eps)
def _scatter_add(tgt, idx, src, axis=0):
    return tgt.clone().index_add_(axis, idx, src)
def _segment_sum(src, seg, n):
    out = torch.zeros((n,) + src.shape[1:], dtype=src.dtype)
    return out.index_add_(0, seg, src)
def _pad(x, pw):
    flat = tuple(v for pair in reversed(pw) for v in pair)
    return torch.nn.functional.pad(x, flat)

kernel_name = 'concat_heads__ssm_conv_s4d__linear_attn_block__prompt'

def setup_inputs():

    _w = (lambda a: (lambda t: t.to(torch.bfloat16) if t.is_floating_point() else t)(torch.as_tensor(a)))
    def _A_setup():
        Bsz, L, D, N = 1, 2048, 448, 256
        return {
            "u": _w((lambda *s: torch.randn(*s, dtype=torch.bfloat16) * 0.05)(Bsz, L, D)),
            "log_A_real": _w((lambda *s: torch.randn(*s, dtype=torch.bfloat16) * 6.4)(D, N) * 0.5),
            "A_imag": _w((lambda *s: torch.randn(*s, dtype=torch.bfloat16) * 0.05)(D, N) * 3.14),
            "C_real": _w((lambda *s: torch.randn(*s, dtype=torch.bfloat16) * 0.2)(D, N) / N ** 0.5),
            "C_imag": _w((lambda *s: torch.randn(*s, dtype=torch.bfloat16) * 0.2)(D, N) / N ** 0.5),
            "log_dt": _w((lambda *s: torch.randn(*s, dtype=torch.bfloat16) * 0.05)(D) * 0.5 - 4.0),
            "D_skip": _w((lambda *s: torch.randn(*s, dtype=torch.bfloat16) * 0.05)(D)),
        }
    _A_in = _A_setup()

    def _B_setup():
        B, S, D = 1, 2048, 448
        return {
            "x": _w((lambda *s: torch.randn(*s, dtype=torch.bfloat16) * 0.05)(B, S, D)),
            "wqkv": _w((lambda *s: torch.randn(*s, dtype=torch.bfloat16) * 0.8)(D, 3 * D)),
            "wo": _w((lambda *s: torch.randn(*s, dtype=torch.bfloat16) * 0.05)(D, D)),
        }
    _B_in = _B_setup()

    return {
        "A_u": _A_in["u"],
        "A_log_A_real": _A_in["log_A_real"],
        "A_A_imag": _A_in["A_imag"],
        "A_C_real": _A_in["C_real"],
        "A_C_imag": _A_in["C_imag"],
        "A_log_dt": _A_in["log_dt"],
        "A_D_skip": _A_in["D_skip"],
        "B_x": _B_in["x"],
        "B_wqkv": _B_in["wqkv"],
        "B_wo": _B_in["wo"],
    }

def reference(A_u, A_log_A_real, A_A_imag, A_C_real, A_C_imag, A_log_dt, A_D_skip, B_x, B_wqkv, B_wo):
    def _A_ref(u, log_A_real, A_imag, C_real, C_imag, log_dt, D_skip):
        L = u.shape[1]
        dt = torch.exp(log_dt)
        A = -torch.exp(log_A_real) + 1j * A_imag
        C = (C_real + 1j * C_imag) * dt[:, None]
        pos = (lambda x, dt: x.to(dt))(torch.arange(L), log_dt.dtype)
        P = torch.exp((A * dt[:, None])[:, :, None] * pos[None, None, :])
        K = 2.0 * torch.einsum("dn,dnl->dl", C, P).real
        L2 = 2 * L
        u_t = (lambda x, *d: x.permute(*d))(u, 0, 2, 1)
        Kf = (lambda x, *a, **k: torch.fft.rfft(x.float(), *a, **k))(K, L2)
        Uf = (lambda x, *a, **k: torch.fft.rfft(x.float(), *a, **k))(u_t, L2)
        y = (lambda x, *a, **k: torch.fft.irfft(x, *a, **k).to(torch.bfloat16))(Uf * Kf[None, :, :], L2)[:, :, :L]
        y = (lambda x, *d: x.permute(*d))(y, 0, 2, 1)
        return y + u * D_skip[None, None, :]

    def _B_ref(x, wqkv, wo):
        B, S, D = x.shape
        H = 16; Dh = D // H
        qkv = (lambda x, *d: x.permute(*d))((x @ wqkv).reshape(B, S, 3, H, Dh), 2, 0, 3, 1, 4)
        q, k, v = qkv[0], qkv[1], qkv[2]
        phi = lambda t: torch.where(t > 0, t + 1, torch.exp(t)) + 1e-6
        pq, pk = phi(q), phi(k)
        kv = torch.einsum("bhsd,bhse->bhde", pk, v)
        z = torch.einsum("bhsd->bhd", pk)
        num = torch.einsum("bhqd,bhde->bhqe", pq, kv)
        den = torch.einsum("bhqd,bhd->bhq", pq, z)[..., None] + 1e-6
        o = num / den
        return (lambda x, *d: x.permute(*d))(o, 0, 2, 1, 3).reshape(B, S, D) @ wo

    a = _A_ref(A_u, A_log_A_real, A_A_imag, A_C_real, A_C_imag, A_log_dt, A_D_skip)
    b = _B_ref(B_x, B_wqkv, B_wo)
    return torch.concatenate([a, b], axis=-1)
```

```asm
; @launch grid=(256,1,1) block=(512,1,1) lds=163840
.amdgcn_target "amdgcn-amd-amdhsa--gfx950"
.text
.globl concat_heads__ssm_conv_s4d__linear_attn_block__prompt_kernel
.p2align 8
.type concat_heads__ssm_conv_s4d__linear_attn_block__prompt_kernel,@function
concat_heads__ssm_conv_s4d__linear_attn_block__prompt_kernel:
    s_cmp_ge_u32 s2, 256
    s_cbranch_scc1 L_end
    s_load_dwordx16 s[4:19], s[0:1], 0
    s_load_dwordx8 s[20:27], s[0:1], 64
    s_load_dwordx2 s[28:29], s[0:1], 96
    s_getpc_b64 s[34:35]
    s_lshr_b32 s3, s2, 3
    s_and_b32 s34, s34, 0xffffff00
    s_and_b32 s33, s3, 3
    s_lshl_b32 s33, s33, 13
    v_lshlrev_b32 v2, 4, v0
    v_add_u32 v2, s33, v2
    global_load_dword v255, v2, s[34:35]
    v_and_b32 v1, 63, v0
    v_lshrrev_b32 v2, 6, v0
    s_and_b32 s31, s2, 7
    v_readfirstlane_b32 s30, v2
    s_cmp_lt_u32 s3, 16
    s_cbranch_scc1 L_teamB
    s_lshr_b32 s43, s30, 2
    s_and_b32 s32, s3, 15
    s_lshl_b32 s32, s32, 1
    s_add_u32 s32, s32, s43
    s_and_b32 s36, s30, 3
    s_lshr_b32 s37, s36, 1
    s_and_b32 s38, s36, 1
    s_lshl_b32 s40, s31, 5
    s_add_u32 s40, s40, s32
    s_lshl_b32 s44, s40, 2
    s_lshl_b32 s40, s40, 1
    s_add_u32 s40, s40, s37
    s_lshl_b32 s41, s40, 9
    s_lshl_b32 s42, s38, 8
    s_add_u32 s41, s41, s42
    v_lshlrev_b32 v5, 2, v1
    v_add_u32 v6, s41, v5
    v_mov_b32 v7, 0
    s_lshl_b32 s86, s43, 7
    s_mul_i32 s87, s43, 53248
    s_add_u32 s87, s87, 8448
    s_lshl_b32 s100, s43, 12
    s_add_u32 s100, s100, 256
    s_mul_i32 s39, s36, 8704
    s_add_u32 s39, s39, s87
    ds_write_b32 v5, v7
    v_lshrrev_b32 v62, 3, v1
    v_mul_u32_u24 v62, 896, v62
    v_and_b32 v4, 7, v1
    v_lshl_add_u32 v62, v4, 4, v62
    s_lshl_b32 s59, s32, 2
    s_add_u32 s59, s59, s36
    s_mul_i32 s56, s59, 14336
    s_lshl_b32 s57, s31, 7
    s_add_u32 s56, s56, s57
    s_add_u32 s57, s56, 7168
    s_lshl_b32 s101, s30, 12
    s_add_u32 s101, s101, 114944
    s_add_u32 s46, s34, gather_tab-concat_heads__ssm_conv_s4d__linear_attn_block__prompt_kernel
    s_addc_u32 s47, s35, 0
    s_lshl_b32 s45, s36, 11
    v_lshl_add_u32 v63, v1, 4, s45
    s_waitcnt lgkmcnt(0)
    s_barrier
    s_cmp_eq_u32 s31, 7
    s_cselect_b32 s90, s30, 0
    s_cmp_ge_u32 s90, 4
    s_cbranch_scc0 L_a_pf0
    s_and_b32 s90, s3, 15
    s_and_b32 s92, s30, 3
    s_add_u32 s92, s92, 0
    s_min_u32 s92, s92, 6
    v_mul_u32_u24 v14, 37, v1
    v_lshrrev_b32 v13, 9, v14
    v_mad_u32_u24 v12, v13, 7, v1
    v_lshlrev_b32 v12, 7, v12
    s_lshl_b32 s91, s92, 4
    s_add_u32 s91, s91, s90
    s_mul_i32 s91, s91, 10752
    v_add_u32 v12, s91, v12
    s_mov_b32 exec_hi, 0xffffff
    global_load_dword v254, v12, s[20:21] offset:896
    s_mov_b64 exec, -1
    v_mul_u32_u24 v13, 896, v1
    s_lshl_b32 s91, s31, 4
    s_add_u32 s91, s91, s90
    s_mul_i32 s91, s91, 14336
    s_lshl_b32 s92, s92, 7
    s_add_u32 s91, s91, s92
    v_add_u32 v13, s91, v13
    s_mov_b64 exec, 0xffff
    global_load_dword v254, v13, s[18:19]
    s_mov_b64 exec, -1
L_a_pf0:
    s_cmp_eq_u32 s31, 7
    s_cbranch_scc1 L_pack
    global_load_dword v8, v6, s[6:7]
    global_load_dword v9, v6, s[8:9]
    global_load_dword v10, v6, s[10:11]
    global_load_dword v11, v6, s[12:13]
    s_load_dword s50, s[14:15], s44
    s_load_dword s51, s[16:17], s44
    s_mov_b32 s52, s4
    s_and_b32 s53, s5, 0xffff
    s_mov_b32 s54, 1835008
    s_mov_b32 s55, 0x00020000
    s_cmp_lt_u32 s30, 4
    s_cbranch_scc0 L_a_p0
    s_setprio 1
    s_add_u32 m0, s45, 131328
    s_nop 0
    global_load_lds_dwordx4 v63, s[46:47]
    global_load_lds_dwordx4 v63, s[46:47] offset:1024
    s_branch L_a_p1
L_a_p0:
    s_and_b32 s90, s3, 15
    s_and_b32 s92, s30, 3
    s_add_u32 s92, s92, 0
    s_min_u32 s92, s92, 6
    v_mul_u32_u24 v14, 37, v1
    v_lshrrev_b32 v13, 9, v14
    v_mad_u32_u24 v12, v13, 7, v1
    v_lshlrev_b32 v12, 7, v12
    s_lshl_b32 s91, s92, 4
    s_add_u32 s91, s91, s90
    s_mul_i32 s91, s91, 10752
    v_add_u32 v12, s91, v12
    s_mov_b32 exec_hi, 0xffffff
    global_load_dword v254, v12, s[20:21] offset:896
    s_mov_b64 exec, -1
    v_mul_u32_u24 v13, 896, v1
    s_lshl_b32 s91, s31, 4
    s_add_u32 s91, s91, s90
    s_mul_i32 s91, s91, 14336
    s_lshl_b32 s92, s92, 7
    s_add_u32 s91, s91, s92
    v_add_u32 v13, s91, v13
    s_mov_b64 exec, 0xffff
    global_load_dword v254, v13, s[18:19]
    s_mov_b64 exec, -1
    s_and_b32 s90, s3, 15
    s_and_b32 s92, s30, 3
    s_add_u32 s92, s92, 4
    s_min_u32 s92, s92, 6
    v_mul_u32_u24 v14, 37, v1
    v_lshrrev_b32 v13, 9, v14
    v_mad_u32_u24 v12, v13, 7, v1
    v_lshlrev_b32 v12, 7, v12
    s_lshl_b32 s91, s92, 4
    s_add_u32 s91, s91, s90
    s_mul_i32 s91, s91, 10752
    v_add_u32 v12, s91, v12
    s_mov_b32 exec_hi, 0xffffff
    global_load_dword v254, v12, s[20:21] offset:896
    s_mov_b64 exec, -1
    v_mul_u32_u24 v13, 896, v1
    s_lshl_b32 s91, s31, 4
    s_add_u32 s91, s91, s90
    s_mul_i32 s91, s91, 14336
    s_lshl_b32 s92, s92, 7
    s_add_u32 s91, s91, s92
    v_add_u32 v13, s91, v13
    s_mov_b64 exec, 0xffff
    global_load_dword v254, v13, s[18:19]
    s_mov_b64 exec, -1
    v_lshrrev_b32 v13, 8, v14
    v_mad_u32_u24 v12, v13, 14, v1
    v_lshlrev_b32 v12, 7, v12
    s_lshl_b32 s90, s90, 2
    s_and_b32 s92, s30, 3
    s_add_u32 s90, s90, s92
    s_mul_i32 s90, s90, 18816
    v_add_u32 v12, s90, v12
    s_mov_b32 exec_hi, 0x1ffff
    global_load_dword v254, v12, s[20:21]
    s_mov_b64 exec, -1
L_a_p1:
    s_branch L_teamA
L_teamB:
    s_memrealtime s[44:45]
    s_lshl_b32 s48, s31, 1
    s_and_b32 s54, s3, 1
    s_add_u32 s48, s48, s54
    s_and_b32 s53, s30, 3
    s_lshr_b32 s57, s30, 2
    s_and_b32 s49, s3, 14
    s_mul_i32 s52, s49, 56
    s_add_u32 s49, s49, s57
    s_add_u32 s50, s3, s31
    s_mul_hi_u32 s54, s50, 0x24924925
    s_mul_i32 s54, s54, 7
    s_sub_u32 s50, s50, s54
    s_mov_b32 s50, 0
    v_lshrrev_b32 v240, 3, v1
    v_mul_u32_u24 v2, 2688, v240
    v_and_b32 v242, 7, v1
    v_bfe_u32 v241, v1, 4, 1
    v_lshlrev_b32 v241, 2, v241
    v_xor_b32 v241, v241, v242
    v_min_u32 v241, 6, v241
    v_lshl_add_u32 v2, v241, 4, v2
    v_mul_u32_u24 v240, 896, v240
    v_lshrrev_b32 v241, 4, v1
    v_xor_b32 v241, v241, v242
    v_lshl_add_u32 v3, v241, 4, v240
    v_xor_b32 v241, 4, v241
    v_lshl_add_u32 v4, v241, 4, v240
    v_add_u32 v4, 7168, v4
    s_lshl_b32 s54, s48, 3
    s_add_u32 s54, s54, s30
    s_mul_i32 s96, s54, 14336
    s_mul_i32 s59, s53, 43008
    s_add_u32 s54, s57, 1
    s_mul_i32 s54, s54, 896
    s_add_u32 s59, s59, s54
    s_add_u32 s59, s59, s52
    s_lshl_b32 s97, s30, 11
    s_mov_b32 s51, s50
    s_lshl_b32 s46, s2, 3
    s_or_b32 s46, s46, s30
    v_mov_b32 v6, 0
    v_mul_u32_u24 v14, 37, v1
    v_lshrrev_b32 v14, 8, v14
    v_mul_u32_u24 v15, 1337, v14
    v_add_lshl_u32 v15, v15, v1, 7
    v_and_b32 v13, 1, v1
    v_mul_u32_u24 v13, 832, v13
    v_lshl_add_u32 v13, v1, 6, v13
    s_waitcnt lgkmcnt(0)
    s_mov_b32 s40, s20
    s_and_b32 s41, s21, 0xffff
    s_mov_b32 s42, 1204224
    s_mov_b32 s43, 0x00020000
    s_mov_b32 s36, s18
    s_and_b32 s37, s19, 0xffff
    s_mov_b32 s38, 1835008
    s_mov_b32 s39, 0x00020000
    s_cmp_eq_u32 s46, 0
    s_cbranch_scc0 L_b_nn
    s_or_b32 s44, s44, 1
    v_mov_b32 v5, s44
    s_mov_b64 exec, 1
    global_store_dword v6, v5, s[26:27] sc1
    s_mov_b64 exec, -1
L_b_nn:
    s_mul_i32 s56, s51, 172032
    s_add_u32 s56, s56, s59
    s_add_u32 m0, s97, 16384
    s_lshl_b32 s55, s51, 7
    buffer_load_dwordx4 v2, s[40:43], s56 offen lds
    s_add_u32 m0, s97, 17408
    s_add_u32 s56, s56, 21504
    buffer_load_dwordx4 v2, s[40:43], s56 offen lds
    s_add_u32 m0, s97, 0
    s_add_u32 s55, s55, s96
    buffer_load_dwordx4 v3, s[36:39], s55 offen lds
    s_add_u32 m0, s97, 1024
    s_add_u32 s51, s51, 1
    s_cmp_ge_u32 s51, 7
    s_cselect_b32 s51, 0, s51
    buffer_load_dwordx4 v4, s[36:39], s55 offen lds
    s_mul_i32 s56, s51, 172032
    s_add_u32 s56, s56, s59
    s_add_u32 m0, s97, 49152
    s_lshl_b32 s55, s51, 7
    buffer_load_dwordx4 v2, s[40:43], s56 offen lds
    s_add_u32 m0, s97, 50176
    s_add_u32 s56, s56, 21504
    buffer_load_dwordx4 v2, s[40:43], s56 offen lds
    s_add_u32 m0, s97, 32768
    s_add_u32 s55, s55, s96
    buffer_load_dwordx4 v3, s[36:39], s55 offen lds
    s_add_u32 m0, s97, 33792
    s_add_u32 s51, s51, 1
    s_cmp_ge_u32 s51, 7
    s_cselect_b32 s51, 0, s51
    buffer_load_dwordx4 v4, s[36:39], s55 offen lds
    s_mov_b32 s4, s28
    s_and_b32 s5, s29, 0xffff
    s_mov_b32 s6, 268435456
    s_mov_b32 s7, 0x00020000
    s_mov_b32 s8, s24
    s_and_b32 s9, s25, 0xffff
    s_mov_b32 s10, 3670016
    s_mov_b32 s11, 0x00020000
    v_and_b32 v240, 31, v1
    v_lshlrev_b32 v241, 7, v240
    s_lshl_b32 s54, s53, 12
    v_add_u32 v241, s54, v241
    v_bfe_u32 v242, v240, 1, 3
    v_lshrrev_b32 v243, 5, v1
    v_xor_b32 v242, v242, v243
    v_xor_b32 v244, 0, v242
    v_lshl_add_u32 v7, v244, 4, v241
    v_xor_b32 v244, 2, v242
    v_lshl_add_u32 v8, v244, 4, v241
    v_xor_b32 v244, 4, v242
    v_lshl_add_u32 v9, v244, 4, v241
    v_xor_b32 v244, 6, v242
    v_lshl_add_u32 v10, v244, 4, v241
    v_bfe_u32 v240, v1, 2, 2
    v_lshl_add_u32 v241, v243, 3, v240
    v_lshlrev_b32 v241, 7, v241
    v_bfe_u32 v242, v1, 4, 1
    v_lshlrev_b32 v242, 5, v242
    v_and_b32 v244, 3, v1
    v_lshl_add_u32 v242, v244, 3, v242
    s_mul_i32 s54, s57, 56
    v_add_u32 v242, s54, v242
    v_bfe_u32 v244, v1, 3, 1
    v_lshlrev_b32 v244, 6, v244
    v_xor_b32 v242, v242, v244
    v_add_u32 v11, v241, v242
    v_add_u32 v12, 65536, v11
    v_add_u32 v248, 65536, v7
    v_add_u32 v249, 65536, v8
    v_add_u32 v250, 65536, v9
    v_add_u32 v251, 65536, v10
    v_lshlrev_b32 v14, 4, v1
    v_lshlrev_b32 v13, 2, v1
    s_mov_b32 s54, 0x358637bd
    v_mov_b32 v128, s54
    v_mov_b32 v160, s54
    v_mov_b32 v129, s54
    v_mov_b32 v161, s54
    v_mov_b32 v130, s54
    v_mov_b32 v162, s54
    v_mov_b32 v131, s54
    v_mov_b32 v163, s54
    v_mov_b32 v132, s54
    v_mov_b32 v164, s54
    v_mov_b32 v133, s54
    v_mov_b32 v165, s54
    v_mov_b32 v134, s54
    v_mov_b32 v166, s54
    v_mov_b32 v135, s54
    v_mov_b32 v167, s54
    v_mov_b32 v136, s54
    v_mov_b32 v168, s54
    v_mov_b32 v137, s54
    v_mov_b32 v169, s54
    v_mov_b32 v138, s54
    v_mov_b32 v170, s54
    v_mov_b32 v139, s54
    v_mov_b32 v171, s54
    v_mov_b32 v140, s54
    v_mov_b32 v172, s54
    v_mov_b32 v141, s54
    v_mov_b32 v173, s54
    v_mov_b32 v142, s54
    v_mov_b32 v174, s54
    v_mov_b32 v143, s54
    v_mov_b32 v175, s54
    s_mul_i32 s58, s30, 21504
    s_add_u32 s58, s58, s52
    s_lshl_b32 s47, s30, 10
    s_waitcnt vmcnt(4)
    s_barrier
    ds_read_b128 v[16:19], v7 offset:0
    ds_read_b64_tr_b16 v[176:177], v11 offset:16384
    ds_read_b64_tr_b16 v[178:179], v11 offset:16896
    ds_read_b64_tr_b16 v[180:181], v11 offset:24576
    ds_read_b64_tr_b16 v[182:183], v11 offset:25088
    ds_read_b128 v[20:23], v8 offset:0
    ds_read_b64_tr_b16 v[184:185], v11 offset:18432
    ds_read_b64_tr_b16 v[186:187], v11 offset:18944
    ds_read_b64_tr_b16 v[188:189], v11 offset:26624
    ds_read_b64_tr_b16 v[190:191], v11 offset:27136
    ds_read_b128 v[24:27], v9 offset:0
    ds_read_b64_tr_b16 v[192:193], v11 offset:20480
    ds_read_b64_tr_b16 v[194:195], v11 offset:20992
    ds_read_b64_tr_b16 v[196:197], v11 offset:28672
    ds_read_b64_tr_b16 v[198:199], v11 offset:29184
    ds_read_b128 v[28:31], v10 offset:0
    ds_read_b64_tr_b16 v[200:201], v11 offset:22528
    ds_read_b64_tr_b16 v[202:203], v11 offset:23040
    ds_read_b64_tr_b16 v[204:205], v11 offset:30720
    ds_read_b64_tr_b16 v[206:207], v11 offset:31232
    s_waitcnt lgkmcnt(0)
    s_mul_i32 s56, s51, 172032
    s_add_u32 s56, s56, s59
    s_add_u32 m0, s97, 81920
    s_lshl_b32 s55, s51, 7
    buffer_load_dwordx4 v2, s[40:43], s56 offen lds
    s_add_u32 m0, s97, 82944
    s_add_u32 s56, s56, 21504
    buffer_load_dwordx4 v2, s[40:43], s56 offen lds
    s_add_u32 m0, s97, 65536
    s_add_u32 s55, s55, s96
    buffer_load_dwordx4 v3, s[36:39], s55 offen lds
    s_add_u32 m0, s97, 66560
    s_add_u32 s51, s51, 1
    s_cmp_ge_u32 s51, 7
    s_cselect_b32 s51, 0, s51
    buffer_load_dwordx4 v4, s[36:39], s55 offen lds
    s_waitcnt vmcnt(4)
    s_barrier
    v_mfma_f32_32x32x16_bf16 v[128:143], v[16:19], v[176:179], v[128:143]
    ds_read_b128 v[32:35], v7 offset:32768
    ds_read_b64_tr_b16 v[208:209], v11 offset:49152
    v_mfma_f32_32x32x16_bf16 v[144:159], v[16:19], v[180:183], 0
    ds_read_b64_tr_b16 v[210:211], v11 offset:49664
    ds_read_b64_tr_b16 v[212:213], v11 offset:57344
    ds_read_b64_tr_b16 v[214:215], v11 offset:57856
    v_mfma_f32_32x32x16_bf16 v[128:143], v[20:23], v[184:187], v[128:143]
    ds_read_b128 v[36:39], v8 offset:32768
    ds_read_b64_tr_b16 v[216:217], v11 offset:51200
    v_mfma_f32_32x32x16_bf16 v[144:159], v[20:23], v[188:191], v[144:159]
    ds_read_b64_tr_b16 v[218:219], v11 offset:51712
    ds_read_b64_tr_b16 v[220:221], v11 offset:59392
    ds_read_b64_tr_b16 v[222:223], v11 offset:59904
    v_mfma_f32_32x32x16_bf16 v[128:143], v[24:27], v[192:195], v[128:143]
    ds_read_b128 v[40:43], v9 offset:32768
    ds_read_b64_tr_b16 v[224:225], v11 offset:53248
    v_mfma_f32_32x32x16_bf16 v[144:159], v[24:27], v[196:199], v[144:159]
    ds_read_b64_tr_b16 v[226:227], v11 offset:53760
    ds_read_b64_tr_b16 v[228:229], v11 offset:61440
    ds_read_b64_tr_b16 v[230:231], v11 offset:61952
    v_mfma_f32_32x32x16_bf16 v[128:143], v[28:31], v[200:203], v[128:143]
    ds_read_b128 v[44:47], v10 offset:32768
    ds_read_b64_tr_b16 v[232:233], v11 offset:55296
    v_mfma_f32_32x32x16_bf16 v[144:159], v[28:31], v[204:207], v[144:159]
    ds_read_b64_tr_b16 v[234:235], v11 offset:55808
    ds_read_b64_tr_b16 v[236:237], v11 offset:63488
    ds_read_b64_tr_b16 v[238:239], v11 offset:64000
    s_waitcnt lgkmcnt(0)
    global_load_dword v252, v6, s[26:27] sc1
    s_mul_i32 s56, s51, 172032
    s_add_u32 s56, s56, s59
    s_add_u32 m0, s97, 114688
    s_lshl_b32 s55, s51, 7
    buffer_load_dwordx4 v2, s[40:43], s56 offen lds
    s_add_u32 m0, s97, 115712
    s_add_u32 s56, s56, 21504
    buffer_load_dwordx4 v2, s[40:43], s56 offen lds
    s_add_u32 m0, s97, 98304
    s_add_u32 s55, s55, s96
    buffer_load_dwordx4 v3, s[36:39], s55 offen lds
    s_add_u32 m0, s97, 99328
    s_add_u32 s51, s51, 1
    s_cmp_ge_u32 s51, 7
    s_cselect_b32 s51, 0, s51
    buffer_load_dwordx4 v4, s[36:39], s55 offen lds
    s_mul_i32 s56, s51, 172032
    s_add_u32 s56, s56, s59
    s_add_u32 m0, s97, 16384
    s_lshl_b32 s55, s51, 7
    buffer_load_dwordx4 v2, s[40:43], s56 offen lds
    s_add_u32 m0, s97, 17408
    s_add_u32 s56, s56, 21504
    buffer_load_dwordx4 v2, s[40:43], s56 offen lds
    s_add_u32 m0, s97, 0
    s_add_u32 s55, s55, s96
    buffer_load_dwordx4 v3, s[36:39], s55 offen lds
    s_add_u32 m0, s97, 1024
    s_add_u32 s51, s51, 1
    s_cmp_ge_u32 s51, 7
    s_cselect_b32 s51, 0, s51
    buffer_load_dwordx4 v4, s[36:39], s55 offen lds
    s_waitcnt vmcnt(9)
    s_barrier
    v_mfma_f32_32x32x16_bf16 v[128:143], v[32:35], v[208:211], v[128:143]
    ds_read_b128 v[48:51], v248 offset:0
    ds_read_b64_tr_b16 v[176:177], v12 offset:16384
    v_mfma_f32_32x32x16_bf16 v[144:159], v[32:35], v[212:215], v[144:159]
    ds_read_b64_tr_b16 v[178:179], v12 offset:16896
    ds_read_b64_tr_b16 v[180:181], v12 offset:24576
    ds_read_b64_tr_b16 v[182:183], v12 offset:25088
    v_mfma_f32_32x32x16_bf16 v[128:143], v[36:39], v[216:219], v[128:143]
    ds_read_b128 v[52:55], v249 offset:0
    ds_read_b64_tr_b16 v[184:185], v12 offset:18432
    v_mfma_f32_32x32x16_bf16 v[144:159], v[36:39], v[220:223], v[144:159]
    ds_read_b64_tr_b16 v[186:187], v12 offset:18944
    ds_read_b64_tr_b16 v[188:189], v12 offset:26624
    ds_read_b64_tr_b16 v[190:191], v12 offset:27136
    v_mfma_f32_32x32x16_bf16 v[128:143], v[40:43], v[224:227], v[128:143]
    ds_read_b128 v[56:59], v250 offset:0
    ds_read_b64_tr_b16 v[192:193], v12 offset:20480
    v_mfma_f32_32x32x16_bf16 v[144:159], v[40:43], v[228:231], v[144:159]
    ds_read_b64_tr_b16 v[194:195], v12 offset:20992
    ds_read_b64_tr_b16 v[196:197], v12 offset:28672
    ds_read_b64_tr_b16 v[198:199], v12 offset:29184
    v_mfma_f32_32x32x16_bf16 v[128:143], v[44:47], v[232:235], v[128:143]
    ds_read_b128 v[60:63], v251 offset:0
    ds_read_b64_tr_b16 v[200:201], v12 offset:22528
    v_mfma_f32_32x32x16_bf16 v[144:159], v[44:47], v[236:239], v[144:159]
    ds_read_b64_tr_b16 v[202:203], v12 offset:23040
    ds_read_b64_tr_b16 v[204:205], v12 offset:30720
    ds_read_b64_tr_b16 v[206:207], v12 offset:31232
    s_waitcnt lgkmcnt(0)
    s_mul_i32 s56, s51, 172032
    s_add_u32 s56, s56, s59
    s_add_u32 m0, s97, 49152
    s_lshl_b32 s55, s51, 7
    buffer_load_dwordx4 v2, s[40:43], s56 offen lds
    s_add_u32 m0, s97, 50176
    s_add_u32 s56, s56, 21504
    buffer_load_dwordx4 v2, s[40:43], s56 offen lds
    s_add_u32 m0, s97, 32768
    s_add_u32 s55, s55, s96
    buffer_load_dwordx4 v3, s[36:39], s55 offen lds
    s_add_u32 m0, s97, 33792
    s_add_u32 s51, s51, 1
    s_cmp_ge_u32 s51, 7
    s_cselect_b32 s51, 0, s51
    buffer_load_dwordx4 v4, s[36:39], s55 offen lds
    s_waitcnt vmcnt(8)
    s_barrier
    v_mfma_f32_32x32x16_bf16 v[128:143], v[48:51], v[176:179], v[128:143]
    ds_read_b128 v[64:67], v248 offset:32768
    ds_read_b64_tr_b16 v[208:209], v12 offset:49152
    v_mfma_f32_32x32x16_bf16 v[144:159], v[48:51], v[180:183], v[144:159]
    ds_read_b64_tr_b16 v[210:211], v12 offset:49664
    ds_read_b64_tr_b16 v[212:213], v12 offset:57344
    ds_read_b64_tr_b16 v[214:215], v12 offset:57856
    v_mfma_f32_32x32x16_bf16 v[128:143], v[52:55], v[184:187], v[128:143]
    ds_read_b128 v[68:71], v249 offset:32768
    ds_read_b64_tr_b16 v[216:217], v12 offset:51200
    v_mfma_f32_32x32x16_bf16 v[144:159], v[52:55], v[188:191], v[144:159]
    ds_read_b64_tr_b16 v[218:219], v12 offset:51712
    ds_read_b64_tr_b16 v[220:221], v12 offset:59392
    ds_read_b64_tr_b16 v[222:223], v12 offset:59904
    v_mfma_f32_32x32x16_bf16 v[128:143], v[56:59], v[192:195], v[128:143]
    ds_read_b128 v[72:75], v250 offset:32768
    ds_read_b64_tr_b16 v[224:225], v12 offset:53248
    v_mfma_f32_32x32x16_bf16 v[144:159], v[56:59], v[196:199], v[144:159]
    ds_read_b64_tr_b16 v[226:227], v12 offset:53760
    ds_read_b64_tr_b16 v[228:229], v12 offset:61440
    ds_read_b64_tr_b16 v[230:231], v12 offset:61952
    v_mfma_f32_32x32x16_bf16 v[128:143], v[60:63], v[200:203], v[128:143]
    ds_read_b128 v[76:79], v251 offset:32768
    ds_read_b64_tr_b16 v[232:233], v12 offset:55296
    v_mfma_f32_32x32x16_bf16 v[144:159], v[60:63], v[204:207], v[144:159]
    ds_read_b64_tr_b16 v[234:235], v12 offset:55808
    ds_read_b64_tr_b16 v[236:237], v12 offset:63488
    ds_read_b64_tr_b16 v[238:239], v12 offset:64000
    s_waitcnt lgkmcnt(0)
    s_mul_i32 s56, s51, 172032
    s_add_u32 s56, s56, s59
    s_add_u32 m0, s97, 81920
    s_lshl_b32 s55, s51, 7
    buffer_load_dwordx4 v2, s[40:43], s56 offen lds
    s_add_u32 m0, s97, 82944
    s_add_u32 s56, s56, 21504
    buffer_load_dwordx4 v2, s[40:43], s56 offen lds
    s_add_u32 m0, s97, 65536
    s_add_u32 s55, s55, s96
    buffer_load_dwordx4 v3, s[36:39], s55 offen lds
    s_add_u32 m0, s97, 66560
    s_add_u32 s51, s51, 1
    s_cmp_ge_u32 s51, 7
    s_cselect_b32 s51, 0, s51
    buffer_load_dwordx4 v4, s[36:39], s55 offen lds
    s_waitcnt vmcnt(8)
    s_barrier
    v_mfma_f32_32x32x16_bf16 v[128:143], v[64:67], v[208:211], v[128:143]
    ds_read_b128 v[80:83], v7 offset:0
    ds_read_b64_tr_b16 v[176:177], v11 offset:16384
    v_mfma_f32_32x32x16_bf16 v[144:159], v[64:67], v[212:215], v[144:159]
    ds_read_b64_tr_b16 v[178:179], v11 offset:16896
    ds_read_b64_tr_b16 v[180:181], v11 offset:24576
    ds_read_b64_tr_b16 v[182:183], v11 offset:25088
    v_mfma_f32_32x32x16_bf16 v[128:143], v[68:71], v[216:219], v[128:143]
    ds_read_b128 v[84:87], v8 offset:0
    ds_read_b64_tr_b16 v[184:185], v11 offset:18432
    v_mfma_f32_32x32x16_bf16 v[144:159], v[68:71], v[220:223], v[144:159]
    ds_read_b64_tr_b16 v[186:187], v11 offset:18944
    ds_read_b64_tr_b16 v[188:189], v11 offset:26624
    ds_read_b64_tr_b16 v[190:191], v11 offset:27136
    v_mfma_f32_32x32x16_bf16 v[128:143], v[72:75], v[224:227], v[128:143]
    ds_read_b128 v[88:91], v9 offset:0
    ds_read_b64_tr_b16 v[192:193], v11 offset:20480
    v_mfma_f32_32x32x16_bf16 v[144:159], v[72:75], v[228:231], v[144:159]
    ds_read_b64_tr_b16 v[194:195], v11 offset:20992
    ds_read_b64_tr_b16 v[196:197], v11 offset:28672
    ds_read_b64_tr_b16 v[198:199], v11 offset:29184
    v_mfma_f32_32x32x16_bf16 v[128:143], v[76:79], v[232:235], v[128:143]
    ds_read_b128 v[92:95], v10 offset:0
    ds_read_b64_tr_b16 v[200:201], v11 offset:22528
    v_mfma_f32_32x32x16_bf16 v[144:159], v[76:79], v[236:239], v[144:159]
    ds_read_b64_tr_b16 v[202:203], v11 offset:23040
    ds_read_b64_tr_b16 v[204:205], v11 offset:30720
    ds_read_b64_tr_b16 v[206:207], v11 offset:31232
    s_waitcnt lgkmcnt(0)
    s_mul_i32 s56, s51, 172032
    s_add_u32 s56, s56, s58
    s_add_u32 m0, s47, 98304
    s_add_u32 s51, s51, 1
    s_cmp_ge_u32 s51, 7
    s_cselect_b32 s51, 0, s51
    buffer_load_dwordx4 v2, s[40:43], s56 offen lds
    s_mul_i32 s56, s51, 172032
    s_add_u32 s56, s56, s58
    s_add_u32 m0, s47, 106496
    s_add_u32 s51, s51, 1
    s_cmp_ge_u32 s51, 7
    s_cselect_b32 s51, 0, s51
    buffer_load_dwordx4 v2, s[40:43], s56 offen lds
    s_mul_i32 s56, s51, 172032
    s_add_u32 s56, s56, s58
    s_add_u32 m0, s47, 114688
    s_add_u32 s51, s51, 1
    s_cmp_ge_u32 s51, 7
    s_cselect_b32 s51, 0, s51
    buffer_load_dwordx4 v2, s[40:43], s56 offen lds
    s_mul_i32 s56, s51, 172032
    s_add_u32 s56, s56, s58
    s_add_u32 m0, s47, 122880
    s_add_u32 s51, s51, 1
    s_cmp_ge_u32 s51, 7
    s_cselect_b32 s51, 0, s51
    buffer_load_dwordx4 v2, s[40:43], s56 offen lds
    s_waitcnt vmcnt(8)
    s_barrier
    v_mfma_f32_32x32x16_bf16 v[128:143], v[80:83], v[176:179], v[128:143]
    ds_read_b128 v[96:99], v7 offset:32768
    ds_read_b64_tr_b16 v[208:209], v11 offset:49152
    v_mfma_f32_32x32x16_bf16 v[144:159], v[80:83], v[180:183], v[144:159]
    ds_read_b64_tr_b16 v[210:211], v11 offset:49664
    ds_read_b64_tr_b16 v[212:213], v11 offset:57344
    ds_read_b64_tr_b16 v[214:215], v11 offset:57856
    v_mfma_f32_32x32x16_bf16 v[128:143], v[84:87], v[184:187], v[128:143]
    ds_read_b128 v[100:103], v8 offset:32768
    ds_read_b64_tr_b16 v[216:217], v11 offset:51200
    v_mfma_f32_32x32x16_bf16 v[144:159], v[84:87], v[188:191], v[144:159]
    ds_read_b64_tr_b16 v[218:219], v11 offset:51712
    ds_read_b64_tr_b16 v[220:221], v11 offset:59392
    ds_read_b64_tr_b16 v[222:223], v11 offset:59904
    v_mfma_f32_32x32x16_bf16 v[128:143], v[88:91], v[192:195], v[128:143]
    ds_read_b128 v[104:107], v9 offset:32768
    ds_read_b64_tr_b16 v[224:225], v11 offset:53248
    v_mfma_f32_32x32x16_bf16 v[144:159], v[88:91], v[196:199], v[144:159]
    ds_read_b64_tr_b16 v[226:227], v11 offset:53760
    ds_read_b64_tr_b16 v[228:229], v11 offset:61440
    ds_read_b64_tr_b16 v[230:231], v11 offset:61952
    v_mfma_f32_32x32x16_bf16 v[128:143], v[92:95], v[200:203], v[128:143]
    ds_read_b128 v[108:111], v10 offset:32768
    ds_read_b64_tr_b16 v[232:233], v11 offset:55296
    v_mfma_f32_32x32x16_bf16 v[144:159], v[92:95], v[204:207], v[144:159]
    ds_read_b64_tr_b16 v[234:235], v11 offset:55808
    ds_read_b64_tr_b16 v[236:237], v11 offset:63488
    ds_read_b64_tr_b16 v[238:239], v11 offset:64000
    s_waitcnt lgkmcnt(0)
    s_mul_i32 s56, s51, 172032
    s_add_u32 s56, s56, s58
    s_add_u32 m0, s47, 0
    s_add_u32 s51, s51, 1
    s_cmp_ge_u32 s51, 7
    s_cselect_b32 s51, 0, s51
    buffer_load_dwordx4 v2, s[40:43], s56 offen lds
    s_mul_i32 s56, s51, 172032
    s_add_u32 s56, s56, s58
    s_add_u32 m0, s47, 8192
    s_add_u32 s51, s51, 1
    s_cmp_ge_u32 s51, 7
    s_cselect_b32 s51, 0, s51
    buffer_load_dwordx4 v2, s[40:43], s56 offen lds
    s_mul_i32 s56, s51, 172032
    s_add_u32 s56, s56, s58
    s_add_u32 m0, s47, 16384
    s_add_u32 s51, s51, 1
    s_cmp_ge_u32 s51, 7
    s_cselect_b32 s51, 0, s51
    buffer_load_dwordx4 v2, s[40:43], s56 offen lds
    s_mov_b32 s91, 0
    s_waitcnt vmcnt(63)
    s_branch Lnc_2
Ln_1:
    global_load_dword v252, v6, s[26:27] sc1
    s_waitcnt vmcnt(0)
Lnc_2:
    v_readfirstlane_b32 s33, v252
    s_add_u32 s91, s91, 1
    s_cmp_gt_u32 s91, 0x4000
    s_cbranch_scc1 Lnd_3
    s_cmp_eq_u32 s33, 0
    s_cbranch_scc1 Ln_1
Lnd_3:
    s_or_b32 s33, s33, 1
    s_cmp_eq_u32 s30, 0
    s_cbranch_scc0 L_b_nc
    s_getreg_b32 s56, hwreg(HW_REG_XCC_ID)
    s_and_b32 s56, s56, 15
    s_lshl_b32 s56, s56, 4
    s_xor_b32 s56, s56, s33
    v_mov_b32 v242, s56
    s_lshl_b32 s56, s31, 5
    s_add_u32 s56, s56, s3
    s_lshl_b32 s56, s56, 3
    s_add_u32 s56, s56, 6029312
    v_mov_b32 v240, s56
    v_mov_b32 v243, v242
    s_mov_b64 exec, 1
    buffer_store_dwordx2 v[242:243], v240, s[4:7], 0 offen
    s_mov_b64 exec, -1
L_b_nc:
    s_waitcnt vmcnt(7)
    s_barrier
    v_mfma_f32_32x32x16_bf16 v[128:143], v[96:99], v[208:211], v[128:143]
    ds_read_b128 v[112:115], v248 offset:0
    ds_read_b64_tr_b16 v[176:177], v12 offset:16384
    v_mfma_f32_32x32x16_bf16 v[144:159], v[96:99], v[212:215], v[144:159]
    ds_read_b64_tr_b16 v[178:179], v12 offset:16896
    ds_read_b64_tr_b16 v[180:181], v12 offset:24576
    ds_read_b64_tr_b16 v[182:183], v12 offset:25088
    v_mfma_f32_32x32x16_bf16 v[128:143], v[100:103], v[216:219], v[128:143]
    ds_read_b128 v[116:119], v249 offset:0
    ds_read_b64_tr_b16 v[184:185], v12 offset:18432
    v_mfma_f32_32x32x16_bf16 v[144:159], v[100:103], v[220:223], v[144:159]
    ds_read_b64_tr_b16 v[186:187], v12 offset:18944
    ds_read_b64_tr_b16 v[188:189], v12 offset:26624
    ds_read_b64_tr_b16 v[190:191], v12 offset:27136
    v_mfma_f32_32x32x16_bf16 v[128:143], v[104:107], v[224:227], v[128:143]
    ds_read_b128 v[120:123], v250 offset:0
    ds_read_b64_tr_b16 v[192:193], v12 offset:20480
    v_mfma_f32_32x32x16_bf16 v[144:159], v[104:107], v[228:231], v[144:159]
    ds_read_b64_tr_b16 v[194:195], v12 offset:20992
    ds_read_b64_tr_b16 v[196:197], v12 offset:28672
    ds_read_b64_tr_b16 v[198:199], v12 offset:29184
    v_mfma_f32_32x32x16_bf16 v[128:143], v[108:111], v[232:235], v[128:143]
    ds_read_b128 v[124:127], v251 offset:0
    ds_read_b64_tr_b16 v[200:201], v12 offset:22528
    v_mfma_f32_32x32x16_bf16 v[144:159], v[108:111], v[236:239], v[144:159]
    ds_read_b64_tr_b16 v[202:203], v12 offset:23040
    ds_read_b64_tr_b16 v[204:205], v12 offset:30720
    ds_read_b64_tr_b16 v[206:207], v12 offset:31232
    s_waitcnt lgkmcnt(0)
    s_lshl_b32 s88, s48, 2
    s_add_u32 s88, s88, s53
    s_lshl_b32 s88, s88, 4
    s_add_u32 s88, s88, s49
    s_lshl_b32 s88, s88, 11
    s_add_u32 s88, s88, 1048576
    v_mfma_f32_32x32x16_bf16 v[128:143], v[112:115], v[176:179], v[128:143]
    v_mfma_f32_32x32x16_bf16 v[128:143], v[116:119], v[184:187], v[128:143]
    v_mfma_f32_32x32x16_bf16 v[128:143], v[120:123], v[192:195], v[128:143]
    v_mfma_f32_32x32x16_bf16 v[128:143], v[124:127], v[200:203], v[128:143]
    v_mfma_f32_32x32x16_bf16 v[144:159], v[112:115], v[180:183], v[144:159]
    v_mfma_f32_32x32x16_bf16 v[144:159], v[116:119], v[188:191], v[144:159]
    v_mfma_f32_32x32x16_bf16 v[144:159], v[120:123], v[196:199], v[144:159]
    v_mfma_f32_32x32x16_bf16 v[144:159], v[124:127], v[204:207], v[144:159]
    s_mov_b32 s54, 0x3fb8aa3b
    s_mov_b32 s55, 0x358637bd
    v_and_b32 v208, 31, v1
    v_cmp_eq_u32 vcc, 28, v208
    s_nop 3
    v_mul_f32 v208, s54, v128
    v_mul_f32 v209, s54, v129
    v_mul_f32 v210, s54, v130
    v_mul_f32 v211, s54, v131
    v_mul_f32 v212, s54, v132
    v_mul_f32 v213, s54, v133
    v_mul_f32 v214, s54, v134
    v_mul_f32 v215, s54, v135
    v_mul_f32 v216, s54, v136
    v_mul_f32 v217, s54, v137
    v_mul_f32 v218, s54, v138
    v_mul_f32 v219, s54, v139
    v_mul_f32 v220, s54, v140
    v_mul_f32 v221, s54, v141
    v_mul_f32 v222, s54, v142
    v_mul_f32 v223, s54, v143
    v_exp_f32 v208, v208 clamp
    v_max_f32 v128, s55, v128
    v_exp_f32 v209, v209 clamp
    v_max_f32 v129, s55, v129
    v_exp_f32 v210, v210 clamp
    v_max_f32 v130, s55, v130
    v_exp_f32 v211, v211 clamp
    v_max_f32 v131, s55, v131
    v_exp_f32 v212, v212 clamp
    v_max_f32 v132, s55, v132
    v_exp_f32 v213, v213 clamp
    v_max_f32 v133, s55, v133
    v_exp_f32 v214, v214 clamp
    v_max_f32 v134, s55, v134
    v_exp_f32 v215, v215 clamp
    v_max_f32 v135, s55, v135
    v_exp_f32 v216, v216 clamp
    v_max_f32 v136, s55, v136
    v_exp_f32 v217, v217 clamp
    v_max_f32 v137, s55, v137
    v_exp_f32 v218, v218 clamp
    v_max_f32 v138, s55, v138
    v_exp_f32 v219, v219 clamp
    v_max_f32 v139, s55, v139
    v_exp_f32 v220, v220 clamp
    v_max_f32 v140, s55, v140
    v_exp_f32 v221, v221 clamp
    v_max_f32 v141, s55, v141
    v_exp_f32 v222, v222 clamp
    v_max_f32 v142, s55, v142
    v_exp_f32 v223, v223 clamp
    v_max_f32 v143, s55, v143
    v_pk_add_f32 v[128:129], v[128:129], v[208:209]
    v_pk_add_f32 v[130:131], v[130:131], v[210:211]
    v_pk_add_f32 v[132:133], v[132:133], v[212:213]
    v_pk_add_f32 v[134:135], v[134:135], v[214:215]
    v_pk_add_f32 v[136:137], v[136:137], v[216:217]
    v_pk_add_f32 v[138:139], v[138:139], v[218:219]
    v_pk_add_f32 v[140:141], v[140:141], v[220:221]
    v_pk_add_f32 v[142:143], v[142:143], v[222:223]
    v_cvt_pk_bf16_f32 v192, v128, v129
    v_cvt_pk_bf16_f32 v193, v130, v131
    v_cvt_pk_bf16_f32 v194, v132, v133
    v_cvt_pk_bf16_f32 v195, v134, v135
    v_cvt_pk_bf16_f32 v196, v136, v137
    v_cvt_pk_bf16_f32 v197, v138, v139
    v_cvt_pk_bf16_f32 v198, v140, v141
    v_cvt_pk_bf16_f32 v199, v142, v143
    v_mov_b32 v208, 0x3f803f80
    v_cvt_pk_bf16_f32 v200, v144, v145
    v_cvt_pk_bf16_f32 v201, v146, v147
    v_cvt_pk_bf16_f32 v202, v148, v149
    v_cvt_pk_bf16_f32 v203, v150, v151
    v_cvt_pk_bf16_f32 v204, v152, v153
    v_cvt_pk_bf16_f32 v205, v154, v155
    v_cvt_pk_bf16_f32 v206, v156, v157
    v_cvt_pk_bf16_f32 v207, v158, v159
    v_cndmask_b32 v200, v200, v208, vcc
    v_cndmask_b32 v201, v201, v208, vcc
    v_cndmask_b32 v202, v202, v208, vcc
    v_cndmask_b32 v203, v203, v208, vcc
    v_cndmask_b32 v204, v204, v208, vcc
    v_cndmask_b32 v205, v205, v208, vcc
    v_cndmask_b32 v206, v206, v208, vcc
    v_cndmask_b32 v207, v207, v208, vcc
    v_mfma_f32_32x32x16_bf16 v[128:143], v[192:195], v[200:203], 0
    s_nop 0
    v_mfma_f32_32x32x16_bf16 v[128:143], v[196:199], v[204:207], v[128:143]
    s_lshl_b32 s56, s30, 12
    s_add_u32 s56, s56, 131072
    v_add_u32 v208, s56, v14
    v_lshrrev_b32 v209, 3, v1
    s_lshl_b32 s56, s53, 3
    v_add_u32 v209, s56, v209
    v_bfe_u32 v210, v1, 2, 1
    v_lshl_add_u32 v210, v210, 5, v209
    v_lshlrev_b32 v210, 4, v210
    v_and_b32 v211, 3, v1
    v_lshl_add_u32 v210, v211, 10, v210
    s_lshl_b32 s56, s57, 14
    s_add_u32 s56, s56, 131072
    v_add_u32 v210, s56, v210
    ds_write_b128 v208, v[128:131] offset:0
    ds_write_b128 v208, v[132:135] offset:1024
    ds_write_b128 v208, v[136:139] offset:2048
    ds_write_b128 v208, v[140:143] offset:3072
    s_waitcnt lgkmcnt(0)
    s_barrier
    ds_read_b128 v[144:147], v210 offset:0
    ds_read_b128 v[148:151], v210 offset:4096
    ds_read_b128 v[152:155], v210 offset:8192
    ds_read_b128 v[156:159], v210 offset:12288
    s_and_b32 s92, s3, 3
    s_lshl_b32 s93, s31, 3
    s_lshr_b32 s56, s3, 2
    s_lshl_b32 s56, s56, 1
    s_add_u32 s93, s93, s56
    s_lshl_b32 s94, s92, 2
    s_add_u32 s94, s94, s53
    s_mul_i32 s95, s94, 32256
    s_add_u32 s95, s95, 5505024
    s_cmp_lt_u32 s94, 14
    s_cselect_b32 s89, s57, 1
    s_cmp_eq_u32 s89, 0
    s_cselect_b32 s94, s95, 0x7f000000
    s_waitcnt lgkmcnt(0)
    v_pk_add_f32 v[144:145], v[144:145], v[148:149]
    v_pk_add_f32 v[152:153], v[152:153], v[156:157]
    v_pk_add_f32 v[146:147], v[146:147], v[150:151]
    v_pk_add_f32 v[154:155], v[154:155], v[158:159]
    v_pk_add_f32 v[144:145], v[144:145], v[152:153]
    v_pk_add_f32 v[146:147], v[146:147], v[154:155]
    v_and_b32 v212, 7, v1
    v_cmp_eq_u32 vcc, 7, v212
    v_cvt_pk_bf16_f32 v214, v144, v145
    v_cvt_pk_bf16_f32 v215, v146, v147
    v_cndmask_b32 v214, v214, 0, vcc
    v_cndmask_b32 v215, v215, 0, vcc
    v_xor_b32 v212, v214, v215
    s_nop 1
    v_xor_b32_dpp v212, v212, v212 quad_perm:[1,0,3,2] row_mask:0xf bank_mask:0xf
    s_nop 1
    v_xor_b32_dpp v212, v212, v212 quad_perm:[2,3,0,1] row_mask:0xf bank_mask:0xf
    s_nop 1
    v_xor_b32_dpp v212, v212, v212 row_half_mirror row_mask:0xf bank_mask:0xf
    v_xor_b32 v212, s33, v212
    v_cndmask_b32 v214, v214, v212, vcc
    s_lshl_b32 s56, s49, 4
    s_add_u32 s56, s56, s48
    s_lshl_b32 s56, s56, 2
    s_add_u32 s56, s56, s53
    s_lshl_b32 s56, s56, 9
    v_lshlrev_b32 v213, 3, v1
    buffer_store_dwordx2 v[214:215], v213, s[4:7], s56 offen sc1
    s_waitcnt vmcnt(1)
    s_barrier
    v_and_b32 v208, 15, v1
    v_lshlrev_b32 v208, 3, v208
    s_lshl_b32 s91, s31, 8
    s_add_u32 s91, s91, 6029312
    buffer_load_dword v252, v208, s[4:7], s91 offen sc1
    v_cmp_lt_u32 s[98:99], 31, v1
    s_cmp_eq_u32 s57, 0
    s_cbranch_scc1 L_b_lo
    s_setprio 2
    v_bfe_u32 v209, v1, 3, 1
    v_lshlrev_b32 v209, 6, v209
    v_xor_b32 v2, v11, v209
    v_subrev_u32 v2, 56, v2
    v_xor_b32 v2, v2, v209
    v_add_u32 v3, 65536, v2
    v_mov_b32 v128, s55
    v_mov_b32 v129, s55
    v_mov_b32 v130, s55
    v_mov_b32 v131, s55
    v_mov_b32 v132, s55
    v_mov_b32 v133, s55
    v_mov_b32 v134, s55
    v_mov_b32 v135, s55
    v_mov_b32 v136, s55
    v_mov_b32 v137, s55
    v_mov_b32 v138, s55
    v_mov_b32 v139, s55
    v_mov_b32 v140, s55
    v_mov_b32 v141, s55
    v_mov_b32 v142, s55
    v_mov_b32 v143, s55
    ds_read_b64_tr_b16 v[176:177], v12 offset:32768
    ds_read_b64_tr_b16 v[178:179], v12 offset:33280
    ds_read_b64_tr_b16 v[180:181], v3 offset:32768
    ds_read_b64_tr_b16 v[182:183], v3 offset:33280
    ds_read_b64_tr_b16 v[184:185], v12 offset:34816
    ds_read_b64_tr_b16 v[186:187], v12 offset:35328
    ds_read_b64_tr_b16 v[188:189], v3 offset:34816
    ds_read_b64_tr_b16 v[190:191], v3 offset:35328
    ds_read_b64_tr_b16 v[192:193], v12 offset:36864
    ds_read_b64_tr_b16 v[194:195], v12 offset:37376
    ds_read_b64_tr_b16 v[196:197], v3 offset:36864
    ds_read_b64_tr_b16 v[198:199], v3 offset:37376
    s_waitcnt lgkmcnt(8)
    v_mfma_f32_32x32x16_bf16 v[160:175], v[176:179], v[16:19], v[160:175]
    v_mfma_f32_32x32x16_bf16 v[128:143], v[180:183], v[16:19], v[128:143]
    ds_read_b64_tr_b16 v[176:177], v12 offset:38912
    ds_read_b64_tr_b16 v[178:179], v12 offset:39424
    ds_read_b64_tr_b16 v[180:181], v3 offset:38912
    ds_read_b64_tr_b16 v[182:183], v3 offset:39424
    s_waitcnt lgkmcnt(8)
    v_mfma_f32_32x32x16_bf16 v[160:175], v[184:187], v[20:23], v[160:175]
    v_mfma_f32_32x32x16_bf16 v[128:143], v[188:191], v[20:23], v[128:143]
    ds_read_b64_tr_b16 v[184:185], v12 offset:40960
    ds_read_b64_tr_b16 v[186:187], v12 offset:41472
    ds_read_b64_tr_b16 v[188:189], v3 offset:40960
    ds_read_b64_tr_b16 v[190:191], v3 offset:41472
    s_waitcnt lgkmcnt(8)
    v_mfma_f32_32x32x16_bf16 v[160:175], v[192:195], v[24:27], v[160:175]
    v_mfma_f32_32x32x16_bf16 v[128:143], v[196:199], v[24:27], v[128:143]
    ds_read_b64_tr_b16 v[192:193], v12 offset:43008
    ds_read_b64_tr_b16 v[194:195], v12 offset:43520
    ds_read_b64_tr_b16 v[196:197], v3 offset:43008
    ds_read_b64_tr_b16 v[198:199], v3 offset:43520
    s_waitcnt lgkmcnt(8)
    v_mfma_f32_32x32x16_bf16 v[160:175], v[176:179], v[28:31], v[160:175]
    v_mfma_f32_32x32x16_bf16 v[128:143], v[180:183], v[28:31], v[128:143]
    ds_read_b64_tr_b16 v[176:177], v12 offset:45056
    ds_read_b64_tr_b16 v[178:179], v12 offset:45568
    ds_read_b64_tr_b16 v[180:181], v3 offset:45056
    ds_read_b64_tr_b16 v[182:183], v3 offset:45568
    s_waitcnt lgkmcnt(8)
    v_mfma_f32_32x32x16_bf16 v[160:175], v[184:187], v[32:35], v[160:175]
    v_mfma_f32_32x32x16_bf16 v[128:143], v[188:191], v[32:35], v[128:143]
    ds_read_b64_tr_b16 v[184:185], v12 offset:47104
    ds_read_b64_tr_b16 v[186:187], v12 offset:47616
    ds_read_b64_tr_b16 v[188:189], v3 offset:47104
    ds_read_b64_tr_b16 v[190:191], v3 offset:47616
    s_waitcnt lgkmcnt(8)
    v_mfma_f32_32x32x16_bf16 v[160:175], v[192:195], v[36:39], v[160:175]
    v_mfma_f32_32x32x16_bf16 v[128:143], v[196:199], v[36:39], v[128:143]
    ds_read_b64_tr_b16 v[192:193], v12 offset:49152
    ds_read_b64_tr_b16 v[194:195], v12 offset:49664
    ds_read_b64_tr_b16 v[196:197], v3 offset:49152
    ds_read_b64_tr_b16 v[198:199], v3 offset:49664
    s_waitcnt lgkmcnt(8)
    v_mfma_f32_32x32x16_bf16 v[160:175], v[176:179], v[40:43], v[160:175]
    v_mfma_f32_32x32x16_bf16 v[128:143], v[180:183], v[40:43], v[128:143]
    ds_read_b64_tr_b16 v[176:177], v12 offset:51200
    ds_read_b64_tr_b16 v[178:179], v12 offset:51712
    ds_read_b64_tr_b16 v[180:181], v3 offset:51200
    ds_read_b64_tr_b16 v[182:183], v3 offset:51712
    s_waitcnt lgkmcnt(8)
    v_mfma_f32_32x32x16_bf16 v[160:175], v[184:187], v[44:47], v[160:175]
    v_mfma_f32_32x32x16_bf16 v[128:143], v[188:191], v[44:47], v[128:143]
    ds_read_b64_tr_b16 v[184:185], v12 offset:53248
    ds_read_b64_tr_b16 v[186:187], v12 offset:53760
    ds_read_b64_tr_b16 v[188:189], v3 offset:53248
    ds_read_b64_tr_b16 v[190:191], v3 offset:53760
    s_waitcnt lgkmcnt(8)
    v_mfma_f32_32x32x16_bf16 v[160:175], v[192:195], v[48:51], v[160:175]
    v_mfma_f32_32x32x16_bf16 v[128:143], v[196:199], v[48:51], v[128:143]
    ds_read_b64_tr_b16 v[192:193], v12 offset:55296
    ds_read_b64_tr_b16 v[194:195], v12 offset:55808
    ds_read_b64_tr_b16 v[196:197], v3 offset:55296
    ds_read_b64_tr_b16 v[198:199], v3 offset:55808
    s_waitcnt lgkmcnt(8)
    v_mfma_f32_32x32x16_bf16 v[160:175], v[176:179], v[52:55], v[160:175]
    v_mfma_f32_32x32x16_bf16 v[128:143], v[180:183], v[52:55], v[128:143]
    ds_read_b64_tr_b16 v[176:177], v12 offset:57344
    ds_read_b64_tr_b16 v[178:179], v12 offset:57856
    ds_read_b64_tr_b16 v[180:181], v3 offset:57344
    ds_read_b64_tr_b16 v[182:183], v3 offset:57856
    s_waitcnt lgkmcnt(8)
    v_mfma_f32_32x32x16_bf16 v[160:175], v[184:187], v[56:59], v[160:175]
    v_mfma_f32_32x32x16_bf16 v[128:143], v[188:191], v[56:59], v[128:143]
    ds_read_b64_tr_b16 v[184:185], v12 offset:59392
    ds_read_b64_tr_b16 v[186:187], v12 offset:59904
    ds_read_b64_tr_b16 v[188:189], v3 offset:59392
    ds_read_b64_tr_b16 v[190:191], v3 offset:59904
    s_waitcnt lgkmcnt(8)
    v_mfma_f32_32x32x16_bf16 v[160:175], v[192:195], v[60:63], v[160:175]
    v_mfma_f32_32x32x16_bf16 v[128:143], v[196:199], v[60:63], v[128:143]
    ds_read_b64_tr_b16 v[192:193], v12 offset:61440
    ds_read_b64_tr_b16 v[194:195], v12 offset:61952
    ds_read_b64_tr_b16 v[196:197], v3 offset:61440
    ds_read_b64_tr_b16 v[198:199], v3 offset:61952
    s_waitcnt lgkmcnt(8)
    v_mfma_f32_32x32x16_bf16 v[160:175], v[176:179], v[64:67], v[160:175]
    v_mfma_f32_32x32x16_bf16 v[128:143], v[180:183], v[64:67], v[128:143]
    ds_read_b64_tr_b16 v[176:177], v12 offset:63488
    ds_read_b64_tr_b16 v[178:179], v12 offset:64000
    ds_read_b64_tr_b16 v[180:181], v3 offset:63488
    ds_read_b64_tr_b16 v[182:183], v3 offset:64000
    s_waitcnt lgkmcnt(8)
    v_mfma_f32_32x32x16_bf16 v[160:175], v[184:187], v[68:71], v[160:175]
    v_mfma_f32_32x32x16_bf16 v[128:143], v[188:191], v[68:71], v[128:143]
    ds_read_b64_tr_b16 v[184:185], v11 offset:0
    ds_read_b64_tr_b16 v[186:187], v11 offset:512
    ds_read_b64_tr_b16 v[188:189], v2 offset:0
    ds_read_b64_tr_b16 v[190:191], v2 offset:512
    s_waitcnt lgkmcnt(8)
    v_mfma_f32_32x32x16_bf16 v[160:175], v[192:195], v[72:75], v[160:175]
    v_mfma_f32_32x32x16_bf16 v[128:143], v[196:199], v[72:75], v[128:143]
    ds_read_b64_tr_b16 v[192:193], v11 offset:2048
    ds_read_b64_tr_b16 v[194:195], v11 offset:2560
    ds_read_b64_tr_b16 v[196:197], v2 offset:2048
    ds_read_b64_tr_b16 v[198:199], v2 offset:2560
    s_waitcnt lgkmcnt(8)
    v_mfma_f32_32x32x16_bf16 v[160:175], v[176:179], v[76:79], v[160:175]
    v_mfma_f32_32x32x16_bf16 v[128:143], v[180:183], v[76:79], v[128:143]
    ds_read_b64_tr_b16 v[176:177], v11 offset:4096
    ds_read_b64_tr_b16 v[178:179], v11 offset:4608
    ds_read_b64_tr_b16 v[180:181], v2 offset:4096
    ds_read_b64_tr_b16 v[182:183], v2 offset:4608
    s_waitcnt lgkmcnt(8)
    v_mfma_f32_32x32x16_bf16 v[160:175], v[184:187], v[80:83], v[160:175]
    v_mfma_f32_32x32x16_bf16 v[128:143], v[188:191], v[80:83], v[128:143]
    ds_read_b64_tr_b16 v[184:185], v11 offset:6144
    ds_read_b64_tr_b16 v[186:187], v11 offset:6656
    ds_read_b64_tr_b16 v[188:189], v2 offset:6144
    ds_read_b64_tr_b16 v[190:191], v2 offset:6656
    s_waitcnt lgkmcnt(8)
    v_mfma_f32_32x32x16_bf16 v[160:175], v[192:195], v[84:87], v[160:175]
    v_mfma_f32_32x32x16_bf16 v[128:143], v[196:199], v[84:87], v[128:143]
    ds_read_b64_tr_b16 v[192:193], v11 offset:8192
    ds_read_b64_tr_b16 v[194:195], v11 offset:8704
    ds_read_b64_tr_b16 v[196:197], v2 offset:8192
    ds_read_b64_tr_b16 v[198:199], v2 offset:8704
    s_waitcnt lgkmcnt(8)
    v_mfma_f32_32x32x16_bf16 v[160:175], v[176:179], v[88:91], v[160:175]
    v_mfma_f32_32x32x16_bf16 v[128:143], v[180:183], v[88:91], v[128:143]
    ds_read_b64_tr_b16 v[176:177], v11 offset:10240
    ds_read_b64_tr_b16 v[178:179], v11 offset:10752
    ds_read_b64_tr_b16 v[180:181], v2 offset:10240
    ds_read_b64_tr_b16 v[182:183], v2 offset:10752
    s_waitcnt lgkmcnt(8)
    v_mfma_f32_32x32x16_bf16 v[160:175], v[184:187], v[92:95], v[160:175]
    v_mfma_f32_32x32x16_bf16 v[128:143], v[188:191], v[92:95], v[128:143]
    ds_read_b64_tr_b16 v[184:185], v11 offset:12288
    ds_read_b64_tr_b16 v[186:187], v11 offset:12800
    ds_read_b64_tr_b16 v[188:189], v2 offset:12288
    ds_read_b64_tr_b16 v[190:191], v2 offset:12800
    s_waitcnt lgkmcnt(8)
    v_mfma_f32_32x32x16_bf16 v[160:175], v[192:195], v[96:99], v[160:175]
    v_mfma_f32_32x32x16_bf16 v[128:143], v[196:199], v[96:99], v[128:143]
    ds_read_b64_tr_b16 v[192:193], v11 offset:14336
    ds_read_b64_tr_b16 v[194:195], v11 offset:14848
    ds_read_b64_tr_b16 v[196:197], v2 offset:14336
    ds_read_b64_tr_b16 v[198:199], v2 offset:14848
    s_waitcnt lgkmcnt(8)
    v_mfma_f32_32x32x16_bf16 v[160:175], v[176:179], v[100:103], v[160:175]
    v_mfma_f32_32x32x16_bf16 v[128:143], v[180:183], v[100:103], v[128:143]
    ds_read_b64_tr_b16 v[176:177], v11 offset:16384
    ds_read_b64_tr_b16 v[178:179], v11 offset:16896
    ds_read_b64_tr_b16 v[180:181], v2 offset:16384
    ds_read_b64_tr_b16 v[182:183], v2 offset:16896
    s_waitcnt lgkmcnt(8)
    v_mfma_f32_32x32x16_bf16 v[160:175], v[184:187], v[104:107], v[160:175]
    v_mfma_f32_32x32x16_bf16 v[128:143], v[188:191], v[104:107], v[128:143]
    ds_read_b64_tr_b16 v[184:185], v11 offset:18432
    ds_read_b64_tr_b16 v[186:187], v11 offset:18944
    ds_read_b64_tr_b16 v[188:189], v2 offset:18432
    ds_read_b64_tr_b16 v[190:191], v2 offset:18944
    s_waitcnt lgkmcnt(8)
    v_mfma_f32_32x32x16_bf16 v[160:175], v[192:195], v[108:111], v[160:175]
    v_mfma_f32_32x32x16_bf16 v[128:143], v[196:199], v[108:111], v[128:143]
    ds_read_b64_tr_b16 v[192:193], v11 offset:20480
    ds_read_b64_tr_b16 v[194:195], v11 offset:20992
    ds_read_b64_tr_b16 v[196:197], v2 offset:20480
    ds_read_b64_tr_b16 v[198:199], v2 offset:20992
    s_waitcnt lgkmcnt(8)
    v_mfma_f32_32x32x16_bf16 v[160:175], v[176:179], v[112:115], v[160:175]
    v_mfma_f32_32x32x16_bf16 v[128:143], v[180:183], v[112:115], v[128:143]
    ds_read_b64_tr_b16 v[176:177], v11 offset:22528
    ds_read_b64_tr_b16 v[178:179], v11 offset:23040
    ds_read_b64_tr_b16 v[180:181], v2 offset:22528
    ds_read_b64_tr_b16 v[182:183], v2 offset:23040
    s_waitcnt lgkmcnt(8)
    v_mfma_f32_32x32x16_bf16 v[160:175], v[184:187], v[116:119], v[160:175]
    v_mfma_f32_32x32x16_bf16 v[128:143], v[188:191], v[116:119], v[128:143]
    s_waitcnt lgkmcnt(4)
    v_mfma_f32_32x32x16_bf16 v[160:175], v[192:195], v[120:123], v[160:175]
    v_mfma_f32_32x32x16_bf16 v[128:143], v[196:199], v[120:123], v[128:143]
    s_waitcnt lgkmcnt(0)
    v_mfma_f32_32x32x16_bf16 v[160:175], v[176:179], v[124:127], v[160:175]
    v_mfma_f32_32x32x16_bf16 v[128:143], v[180:183], v[124:127], v[128:143]
    s_waitcnt vmcnt(0)
    s_getreg_b32 s56, hwreg(HW_REG_XCC_ID)
    s_and_b32 s56, s56, 15
    s_lshl_b32 s56, s56, 4
    s_xor_b32 s56, s56, s33
    v_cmp_ne_u32 vcc, s56, v252
    s_nop 0
    s_cmp_eq_u64 vcc, 0
    s_cselect_b32 s47, 1, 0
    s_sub_u32 s88, s88, 2048
    s_nop 0
    v_mul_f32 v208, s54, v160
    v_mul_f32 v209, s54, v161
    v_mul_f32 v210, s54, v162
    v_mul_f32 v211, s54, v163
    v_mul_f32 v212, s54, v164
    v_mul_f32 v213, s54, v165
    v_mul_f32 v214, s54, v166
    v_mul_f32 v215, s54, v167
    v_mul_f32 v216, s54, v168
    v_mul_f32 v217, s54, v169
    v_mul_f32 v218, s54, v170
    v_mul_f32 v219, s54, v171
    v_mul_f32 v220, s54, v172
    v_mul_f32 v221, s54, v173
    v_mul_f32 v222, s54, v174
    v_mul_f32 v223, s54, v175
    v_exp_f32 v208, v208 clamp
    v_max_f32 v160, s55, v160
    v_exp_f32 v209, v209 clamp
    v_max_f32 v161, s55, v161
    v_exp_f32 v210, v210 clamp
    v_max_f32 v162, s55, v162
    v_exp_f32 v211, v211 clamp
    v_max_f32 v163, s55, v163
    v_exp_f32 v212, v212 clamp
    v_max_f32 v164, s55, v164
    v_exp_f32 v213, v213 clamp
    v_max_f32 v165, s55, v165
    v_exp_f32 v214, v214 clamp
    v_max_f32 v166, s55, v166
    v_exp_f32 v215, v215 clamp
    v_max_f32 v167, s55, v167
    v_exp_f32 v216, v216 clamp
    v_max_f32 v168, s55, v168
    v_exp_f32 v217, v217 clamp
    v_max_f32 v169, s55, v169
    v_exp_f32 v218, v218 clamp
    v_max_f32 v170, s55, v170
    v_exp_f32 v219, v219 clamp
    v_max_f32 v171, s55, v171
    v_exp_f32 v220, v220 clamp
    v_max_f32 v172, s55, v172
    v_exp_f32 v221, v221 clamp
    v_max_f32 v173, s55, v173
    v_exp_f32 v222, v222 clamp
    v_max_f32 v174, s55, v174
    v_exp_f32 v223, v223 clamp
    v_max_f32 v175, s55, v175
    v_pk_add_f32 v[160:161], v[160:161], v[208:209]
    v_pk_add_f32 v[162:163], v[162:163], v[210:211]
    v_pk_add_f32 v[164:165], v[164:165], v[212:213]
    v_pk_add_f32 v[166:167], v[166:167], v[214:215]
    v_pk_add_f32 v[168:169], v[168:169], v[216:217]
    v_pk_add_f32 v[170:171], v[170:171], v[218:219]
    v_pk_add_f32 v[172:173], v[172:173], v[220:221]
    v_pk_add_f32 v[174:175], v[174:175], v[222:223]
    v_cvt_pk_bf16_f32 v192, v160, v161
    v_cvt_pk_bf16_f32 v193, v162, v163
    v_cvt_pk_bf16_f32 v194, v164, v165
    v_cvt_pk_bf16_f32 v195, v166, v167
    v_cvt_pk_bf16_f32 v196, v168, v169
    v_cvt_pk_bf16_f32 v197, v170, v171
    v_cvt_pk_bf16_f32 v198, v172, v173
    v_cvt_pk_bf16_f32 v199, v174, v175
    v_cndmask_b32 v198, v198, 0, s[98:99]
    v_cndmask_b32 v199, v199, 0, s[98:99]
    v_bitop3_b32 v208, v192, v193, v194 bitop3:0x96
    v_bitop3_b32 v208, v208, v195, v196 bitop3:0x96
    v_bitop3_b32 v208, v208, v197, v198 bitop3:0x96
    v_xor_b32 v208, v208, v199
    v_mov_b32 v209, v208
    s_nop 1
    v_permlane32_swap_b32 v208, v209
    v_bitop3_b32 v208, v208, v209, s33 bitop3:0x96
    v_cndmask_b32 v198, v198, v208, s[98:99]
    buffer_store_dwordx4 v[192:195], v14, s[4:7], s88 offen offset:2048
    buffer_store_dwordx4 v[196:199], v14, s[4:7], s88 offen offset:3072
    v_mul_f32 v208, s54, v128
    v_mul_f32 v209, s54, v129
    v_mul_f32 v210, s54, v130
    v_mul_f32 v211, s54, v131
    v_mul_f32 v212, s54, v132
    v_mul_f32 v213, s54, v133
    v_mul_f32 v214, s54, v134
    v_mul_f32 v215, s54, v135
    v_mul_f32 v216, s54, v136
    v_mul_f32 v217, s54, v137
    v_mul_f32 v218, s54, v138
    v_mul_f32 v219, s54, v139
    v_mul_f32 v220, s54, v140
    v_mul_f32 v221, s54, v141
    v_mul_f32 v222, s54, v142
    v_mul_f32 v223, s54, v143
    v_exp_f32 v208, v208 clamp
    v_max_f32 v128, s55, v128
    v_exp_f32 v209, v209 clamp
    v_max_f32 v129, s55, v129
    v_exp_f32 v210, v210 clamp
    v_max_f32 v130, s55, v130
    v_exp_f32 v211, v211 clamp
    v_max_f32 v131, s55, v131
    v_exp_f32 v212, v212 clamp
    v_max_f32 v132, s55, v132
    v_exp_f32 v213, v213 clamp
    v_max_f32 v133, s55, v133
    v_exp_f32 v214, v214 clamp
    v_max_f32 v134, s55, v134
    v_exp_f32 v215, v215 clamp
    v_max_f32 v135, s55, v135
    v_exp_f32 v216, v216 clamp
    v_max_f32 v136, s55, v136
    v_exp_f32 v217, v217 clamp
    v_max_f32 v137, s55, v137
    v_exp_f32 v218, v218 clamp
    v_max_f32 v138, s55, v138
    v_exp_f32 v219, v219 clamp
    v_max_f32 v139, s55, v139
    v_exp_f32 v220, v220 clamp
    v_max_f32 v140, s55, v140
    v_exp_f32 v221, v221 clamp
    v_max_f32 v141, s55, v141
    v_exp_f32 v222, v222 clamp
    v_max_f32 v142, s55, v142
    v_exp_f32 v223, v223 clamp
    v_max_f32 v143, s55, v143
    v_pk_add_f32 v[128:129], v[128:129], v[208:209]
    v_pk_add_f32 v[130:131], v[130:131], v[210:211]
    v_pk_add_f32 v[132:133], v[132:133], v[212:213]
    v_pk_add_f32 v[134:135], v[134:135], v[214:215]
    v_pk_add_f32 v[136:137], v[136:137], v[216:217]
    v_pk_add_f32 v[138:139], v[138:139], v[218:219]
    v_pk_add_f32 v[140:141], v[140:141], v[220:221]
    v_pk_add_f32 v[142:143], v[142:143], v[222:223]
    v_cvt_pk_bf16_f32 v200, v128, v129
    v_cvt_pk_bf16_f32 v201, v130, v131
    v_cvt_pk_bf16_f32 v202, v132, v133
    v_cvt_pk_bf16_f32 v203, v134, v135
    v_cvt_pk_bf16_f32 v204, v136, v137
    v_cvt_pk_bf16_f32 v205, v138, v139
    v_cvt_pk_bf16_f32 v206, v140, v141
    v_cvt_pk_bf16_f32 v207, v142, v143
    v_cndmask_b32 v206, v206, 0, s[98:99]
    v_cndmask_b32 v207, v207, 0, s[98:99]
    v_bitop3_b32 v208, v200, v201, v202 bitop3:0x96
    v_bitop3_b32 v208, v208, v203, v204 bitop3:0x96
    v_bitop3_b32 v208, v208, v205, v206 bitop3:0x96
    v_xor_b32 v208, v208, v207
    v_mov_b32 v209, v208
    s_nop 1
    v_permlane32_swap_b32 v208, v209
    v_bitop3_b32 v208, v208, v209, s33 bitop3:0x96
    v_cndmask_b32 v206, v206, v208, s[98:99]
    buffer_store_dwordx4 v[200:203], v14, s[4:7], s88 offen offset:0
    buffer_store_dwordx4 v[204:207], v14, s[4:7], s88 offen offset:1024
    s_cmp_eq_u32 s47, 1
    s_cbranch_scc1 L_b_npq
    s_add_u32 s88, s88, 16777216
    buffer_store_dwordx4 v[192:195], v14, s[4:7], s88 offen offset:2048 sc1
    buffer_store_dwordx4 v[196:199], v14, s[4:7], s88 offen offset:3072 sc1
    buffer_store_dwordx4 v[200:203], v14, s[4:7], s88 offen offset:0 sc1
    buffer_store_dwordx4 v[204:207], v14, s[4:7], s88 offen offset:1024 sc1
L_b_npq:
    s_waitcnt vmcnt(0)
    s_setprio 2
    s_lshl_b32 s56, s93, 4
    s_lshl_b32 s55, s53, 2
    s_add_u32 s56, s56, s55
    s_lshl_b32 s56, s56, 11
    s_add_u32 s56, s56, 1048576
    v_add_u32 v8, s56, v14
    v_add_u32 v9, 4096, v8
    v_add_u32 v10, 32768, v8
    v_add_u32 v11, 32768, v9
    s_lshl_b32 s56, s31, 15
    s_lshl_b32 s55, s53, 13
    s_add_u32 s56, s56, s55
    s_add_u32 s56, s56, 524288
    v_add_u32 v2, s56, v14
    v_add_u32 v3, 4096, v2
    v_xor_b32 v4, 64, v2
    v_xor_b32 v7, 64, v3
    buffer_load_dwordx4 v[128:131], v8, s[4:7], 0 offen offset:0 sc1
    buffer_load_dwordx4 v[132:135], v8, s[4:7], 0 offen offset:1024 sc1
    buffer_load_dwordx4 v[136:139], v8, s[4:7], 0 offen offset:2048 sc1
    buffer_load_dwordx4 v[140:143], v8, s[4:7], 0 offen offset:3072 sc1
    buffer_load_dwordx4 v[144:147], v9, s[4:7], 0 offen offset:0 sc1
    buffer_load_dwordx4 v[148:151], v9, s[4:7], 0 offen offset:1024 sc1
    buffer_load_dwordx4 v[152:155], v9, s[4:7], 0 offen offset:2048 sc1
    buffer_load_dwordx4 v[156:159], v9, s[4:7], 0 offen offset:3072 sc1
    buffer_load_dwordx4 v[64:67], v10, s[4:7], 0 offen offset:0 sc1
    buffer_load_dwordx4 v[68:71], v10, s[4:7], 0 offen offset:1024 sc1
    buffer_load_dwordx4 v[72:75], v10, s[4:7], 0 offen offset:2048 sc1
    buffer_load_dwordx4 v[76:79], v10, s[4:7], 0 offen offset:3072 sc1
    buffer_load_dwordx4 v[80:83], v11, s[4:7], 0 offen offset:0 sc1
    buffer_load_dwordx4 v[84:87], v11, s[4:7], 0 offen offset:1024 sc1
    buffer_load_dwordx4 v[88:91], v11, s[4:7], 0 offen offset:2048 sc1
    buffer_load_dwordx4 v[92:95], v11, s[4:7], 0 offen offset:3072 sc1
    s_waitcnt vmcnt(14)
    v_bitop3_b32 v208, v128, v129, v130 bitop3:0x96
    v_bitop3_b32 v208, v208, v131, v132 bitop3:0x96
    v_bitop3_b32 v208, v208, v133, v134 bitop3:0x96
    v_xor_b32 v208, v208, v135
    v_mov_b32 v209, v208
    s_waitcnt vmcnt(12)
    v_bitop3_b32 v210, v136, v137, v138 bitop3:0x96
    v_bitop3_b32 v210, v210, v139, v140 bitop3:0x96
    v_bitop3_b32 v210, v210, v141, v142 bitop3:0x96
    v_xor_b32 v210, v210, v143
    v_mov_b32 v211, v210
    s_waitcnt vmcnt(10)
    v_bitop3_b32 v212, v144, v145, v146 bitop3:0x96
    v_bitop3_b32 v212, v212, v147, v148 bitop3:0x96
    v_bitop3_b32 v212, v212, v149, v150 bitop3:0x96
    v_xor_b32 v212, v212, v151
    v_mov_b32 v213, v212
    s_waitcnt vmcnt(8)
    v_bitop3_b32 v214, v152, v153, v154 bitop3:0x96
    v_bitop3_b32 v214, v214, v155, v156 bitop3:0x96
    v_bitop3_b32 v214, v214, v157, v158 bitop3:0x96
    v_xor_b32 v214, v214, v159
    v_mov_b32 v215, v214
    v_permlane32_swap_b32 v208, v209
    v_permlane32_swap_b32 v210, v211
    v_permlane32_swap_b32 v212, v213
    v_permlane32_swap_b32 v214, v215
    v_bitop3_b32 v208, v208, v209, s33 bitop3:0x96
    v_bitop3_b32 v210, v210, v211, s33 bitop3:0x96
    v_bitop3_b32 v212, v212, v213, s33 bitop3:0x96
    v_bitop3_b32 v214, v214, v215, s33 bitop3:0x96
    v_or3_b32 v208, v208, v210, v212
    v_or_b32 v208, v208, v214
    v_cmp_ne_u32 vcc, 0, v208
    s_nop 0
    s_cbranch_vccz L_b_pq_d
    s_mov_b32 s90, 0
    s_mov_b32 s58, 0
L_b_pq:
    s_add_u32 s90, s90, 1
    s_cmp_gt_u32 s90, 0x4000
    s_cbranch_scc1 L_b_pq_t
    s_cmp_gt_u32 s90, 48
    s_cselect_b32 s91, 16777216, 0
    s_xor_b32 s58, s58, s91
    s_sleep 2
    buffer_load_dwordx4 v[128:131], v8, s[4:7], s58 offen offset:0 sc1
    buffer_load_dwordx4 v[132:135], v8, s[4:7], s58 offen offset:1024 sc1
    buffer_load_dwordx4 v[136:139], v8, s[4:7], s58 offen offset:2048 sc1
    buffer_load_dwordx4 v[140:143], v8, s[4:7], s58 offen offset:3072 sc1
    buffer_load_dwordx4 v[144:147], v9, s[4:7], s58 offen offset:0 sc1
    buffer_load_dwordx4 v[148:151], v9, s[4:7], s58 offen offset:1024 sc1
    buffer_load_dwordx4 v[152:155], v9, s[4:7], s58 offen offset:2048 sc1
    buffer_load_dwordx4 v[156:159], v9, s[4:7], s58 offen offset:3072 sc1
    s_waitcnt vmcnt(6)
    v_bitop3_b32 v208, v128, v129, v130 bitop3:0x96
    v_bitop3_b32 v208, v208, v131, v132 bitop3:0x96
    v_bitop3_b32 v208, v208, v133, v134 bitop3:0x96
    v_xor_b32 v208, v208, v135
    v_mov_b32 v209, v208
    s_waitcnt vmcnt(4)
    v_bitop3_b32 v210, v136, v137, v138 bitop3:0x96
    v_bitop3_b32 v210, v210, v139, v140 bitop3:0x96
    v_bitop3_b32 v210, v210, v141, v142 bitop3:0x96
    v_xor_b32 v210, v210, v143
    v_mov_b32 v211, v210
    s_waitcnt vmcnt(2)
    v_bitop3_b32 v212, v144, v145, v146 bitop3:0x96
    v_bitop3_b32 v212, v212, v147, v148 bitop3:0x96
    v_bitop3_b32 v212, v212, v149, v150 bitop3:0x96
    v_xor_b32 v212, v212, v151
    v_mov_b32 v213, v212
    s_waitcnt vmcnt(0)
    v_bitop3_b32 v214, v152, v153, v154 bitop3:0x96
    v_bitop3_b32 v214, v214, v155, v156 bitop3:0x96
    v_bitop3_b32 v214, v214, v157, v158 bitop3:0x96
    v_xor_b32 v214, v214, v159
    v_mov_b32 v215, v214
    v_permlane32_swap_b32 v208, v209
    v_permlane32_swap_b32 v210, v211
    v_permlane32_swap_b32 v212, v213
    v_permlane32_swap_b32 v214, v215
    v_bitop3_b32 v208, v208, v209, s33 bitop3:0x96
    v_bitop3_b32 v210, v210, v211, s33 bitop3:0x96
    v_bitop3_b32 v212, v212, v213, s33 bitop3:0x96
    v_bitop3_b32 v214, v214, v215, s33 bitop3:0x96
    v_or3_b32 v208, v208, v210, v212
    v_or_b32 v208, v208, v214
    v_cmp_ne_u32 vcc, 0, v208
    s_nop 0
    s_cbranch_vccnz L_b_pq
L_b_pq_t:
    s_waitcnt vmcnt(0)
L_b_pq_d:
    v_cndmask_b32 v134, v134, 0, s[98:99]
    v_cndmask_b32 v142, v142, 0, s[98:99]
    v_cndmask_b32 v150, v150, 0, s[98:99]
    v_cndmask_b32 v158, v158, 0, s[98:99]
    s_waitcnt vmcnt(6)
    v_bitop3_b32 v208, v64, v65, v66 bitop3:0x96
    v_bitop3_b32 v208, v208, v67, v68 bitop3:0x96
    v_bitop3_b32 v208, v208, v69, v70 bitop3:0x96
    v_xor_b32 v208, v208, v71
    v_mov_b32 v209, v208
    s_waitcnt vmcnt(4)
    v_bitop3_b32 v210, v72, v73, v74 bitop3:0x96
    v_bitop3_b32 v210, v210, v75, v76 bitop3:0x96
    v_bitop3_b32 v210, v210, v77, v78 bitop3:0x96
    v_xor_b32 v210, v210, v79
    v_mov_b32 v211, v210
    s_waitcnt vmcnt(2)
    v_bitop3_b32 v212, v80, v81, v82 bitop3:0x96
    v_bitop3_b32 v212, v212, v83, v84 bitop3:0x96
    v_bitop3_b32 v212, v212, v85, v86 bitop3:0x96
    v_xor_b32 v212, v212, v87
    v_mov_b32 v213, v212
    s_waitcnt vmcnt(0)
    v_bitop3_b32 v214, v88, v89, v90 bitop3:0x96
    v_bitop3_b32 v214, v214, v91, v92 bitop3:0x96
    v_bitop3_b32 v214, v214, v93, v94 bitop3:0x96
    v_xor_b32 v214, v214, v95
    v_mov_b32 v215, v214
    v_permlane32_swap_b32 v208, v209
    v_permlane32_swap_b32 v210, v211
    v_permlane32_swap_b32 v212, v213
    v_permlane32_swap_b32 v214, v215
    v_bitop3_b32 v208, v208, v209, s33 bitop3:0x96
    v_bitop3_b32 v210, v210, v211, s33 bitop3:0x96
    v_bitop3_b32 v212, v212, v213, s33 bitop3:0x96
    v_bitop3_b32 v214, v214, v215, s33 bitop3:0x96
    v_or3_b32 v208, v208, v210, v212
    v_or_b32 v208, v208, v214
    v_cmp_ne_u32 vcc, 0, v208
    s_nop 0
    s_cbranch_vccz L_b_pq1_d
    s_mov_b32 s90, 0
    s_mov_b32 s58, 0
L_b_pq1:
    s_add_u32 s90, s90, 1
    s_cmp_gt_u32 s90, 0x4000
    s_cbranch_scc1 L_b_pq1_t
    s_cmp_gt_u32 s90, 48
    s_cselect_b32 s91, 16777216, 0
    s_xor_b32 s58, s58, s91
    s_sleep 2
    buffer_load_dwordx4 v[64:67], v10, s[4:7], s58 offen offset:0 sc1
    buffer_load_dwordx4 v[68:71], v10, s[4:7], s58 offen offset:1024 sc1
    buffer_load_dwordx4 v[72:75], v10, s[4:7], s58 offen offset:2048 sc1
    buffer_load_dwordx4 v[76:79], v10, s[4:7], s58 offen offset:3072 sc1
    buffer_load_dwordx4 v[80:83], v11, s[4:7], s58 offen offset:0 sc1
    buffer_load_dwordx4 v[84:87], v11, s[4:7], s58 offen offset:1024 sc1
    buffer_load_dwordx4 v[88:91], v11, s[4:7], s58 offen offset:2048 sc1
    buffer_load_dwordx4 v[92:95], v11, s[4:7], s58 offen offset:3072 sc1
    s_waitcnt vmcnt(6)
    v_bitop3_b32 v208, v64, v65, v66 bitop3:0x96
    v_bitop3_b32 v208, v208, v67, v68 bitop3:0x96
    v_bitop3_b32 v208, v208, v69, v70 bitop3:0x96
    v_xor_b32 v208, v208, v71
    v_mov_b32 v209, v208
    s_waitcnt vmcnt(4)
    v_bitop3_b32 v210, v72, v73, v74 bitop3:0x96
    v_bitop3_b32 v210, v210, v75, v76 bitop3:0x96
    v_bitop3_b32 v210, v210, v77, v78 bitop3:0x96
    v_xor_b32 v210, v210, v79
    v_mov_b32 v211, v210
    s_waitcnt vmcnt(2)
    v_bitop3_b32 v212, v80, v81, v82 bitop3:0x96
    v_bitop3_b32 v212, v212, v83, v84 bitop3:0x96
    v_bitop3_b32 v212, v212, v85, v86 bitop3:0x96
    v_xor_b32 v212, v212, v87
    v_mov_b32 v213, v212
    s_waitcnt vmcnt(0)
    v_bitop3_b32 v214, v88, v89, v90 bitop3:0x96
    v_bitop3_b32 v214, v214, v91, v92 bitop3:0x96
    v_bitop3_b32 v214, v214, v93, v94 bitop3:0x96
    v_xor_b32 v214, v214, v95
    v_mov_b32 v215, v214
    v_permlane32_swap_b32 v208, v209
    v_permlane32_swap_b32 v210, v211
    v_permlane32_swap_b32 v212, v213
    v_permlane32_swap_b32 v214, v215
    v_bitop3_b32 v208, v208, v209, s33 bitop3:0x96
    v_bitop3_b32 v210, v210, v211, s33 bitop3:0x96
    v_bitop3_b32 v212, v212, v213, s33 bitop3:0x96
    v_bitop3_b32 v214, v214, v215, s33 bitop3:0x96
    v_or3_b32 v208, v208, v210, v212
    v_or_b32 v208, v208, v214
    v_cmp_ne_u32 vcc, 0, v208
    s_nop 0
    s_cbranch_vccnz L_b_pq1
L_b_pq1_t:
    s_waitcnt vmcnt(0)
L_b_pq1_d:
    v_cndmask_b32 v70, v70, 0, s[98:99]
    v_cndmask_b32 v78, v78, 0, s[98:99]
    v_cndmask_b32 v86, v86, 0, s[98:99]
    v_cndmask_b32 v94, v94, 0, s[98:99]
    v_mov_b32 v5, 159776
    s_mov_b32 s91, 0
L_kf:
    ds_read_b128 v[208:211], v5
    s_add_u32 s91, s91, 1
    s_cmp_gt_u32 s91, 0x100000
    s_cbranch_scc1 L_kf_d
    s_waitcnt lgkmcnt(0)
    v_xor_b32 v208, s33, v208
    v_xor_b32 v209, s33, v209
    v_xor_b32 v210, s33, v210
    v_xor_b32 v211, s33, v211
    v_or3_b32 v208, v208, v209, v210
    v_or_b32 v208, v208, v211
    v_cmp_ne_u32 vcc, 0, v208
    s_nop 0
    s_cbranch_vccz L_kf_d
    s_sleep 2
    s_branch L_kf
L_kf_d:
    s_waitcnt lgkmcnt(0)
    buffer_load_dwordx4 v[160:163], v2, s[4:7], 0 offen offset:0 sc1
    buffer_load_dwordx4 v[164:167], v2, s[4:7], 0 offen offset:1024 sc1
    buffer_load_dwordx4 v[168:171], v4, s[4:7], 0 offen offset:2048 sc1
    buffer_load_dwordx4 v[172:175], v4, s[4:7], 0 offen offset:3072 sc1
    buffer_load_dwordx4 v[176:179], v3, s[4:7], 0 offen offset:0 sc1
    buffer_load_dwordx4 v[180:183], v3, s[4:7], 0 offen offset:1024 sc1
    buffer_load_dwordx4 v[184:187], v7, s[4:7], 0 offen offset:2048 sc1
    buffer_load_dwordx4 v[188:191], v7, s[4:7], 0 offen offset:3072 sc1
    s_waitcnt vmcnt(6)
    v_bitop3_b32 v208, v160, v161, v162 bitop3:0x96
    v_bitop3_b32 v208, v208, v163, v164 bitop3:0x96
    v_bitop3_b32 v208, v208, v165, v166 bitop3:0x96
    v_xor_b32 v208, v208, v167
    v_mov_b32 v209, v208
    s_waitcnt vmcnt(4)
    v_bitop3_b32 v210, v168, v169, v170 bitop3:0x96
    v_bitop3_b32 v210, v210, v171, v172 bitop3:0x96
    v_bitop3_b32 v210, v210, v173, v174 bitop3:0x96
    v_xor_b32 v210, v210, v175
    v_mov_b32 v211, v210
    s_waitcnt vmcnt(2)
    v_bitop3_b32 v212, v176, v177, v178 bitop3:0x96
    v_bitop3_b32 v212, v212, v179, v180 bitop3:0x96
    v_bitop3_b32 v212, v212, v181, v182 bitop3:0x96
    v_xor_b32 v212, v212, v183
    v_mov_b32 v213, v212
    s_waitcnt vmcnt(0)
    v_bitop3_b32 v214, v184, v185, v186 bitop3:0x96
    v_bitop3_b32 v214, v214, v187, v188 bitop3:0x96
    v_bitop3_b32 v214, v214, v189, v190 bitop3:0x96
    v_xor_b32 v214, v214, v191
    v_mov_b32 v215, v214
    v_permlane32_swap_b32 v208, v209
    v_permlane32_swap_b32 v210, v211
    v_permlane32_swap_b32 v212, v213
    v_permlane32_swap_b32 v214, v215
    v_bitop3_b32 v208, v208, v209, s33 bitop3:0x96
    v_bitop3_b32 v210, v210, v211, s33 bitop3:0x96
    v_bitop3_b32 v212, v212, v213, s33 bitop3:0x96
    v_bitop3_b32 v214, v214, v215, s33 bitop3:0x96
    v_or3_b32 v208, v208, v210, v212
    v_or_b32 v208, v208, v214
    v_cmp_ne_u32 vcc, 0, v208
    s_nop 0
    s_cbranch_vccz L_b_kv_d
    s_mov_b32 s90, 0
    s_mov_b32 s58, 0
L_b_kv:
    s_add_u32 s90, s90, 1
    s_cmp_gt_u32 s90, 0x4000
    s_cbranch_scc1 L_b_kv_t
    s_cmp_gt_u32 s90, 48
    s_cselect_b32 s91, 16777216, 0
    s_xor_b32 s58, s58, s91
    s_sleep 2
    buffer_load_dwordx4 v[160:163], v2, s[4:7], s58 offen offset:0 sc1
    buffer_load_dwordx4 v[164:167], v2, s[4:7], s58 offen offset:1024 sc1
    buffer_load_dwordx4 v[168:171], v4, s[4:7], s58 offen offset:2048 sc1
    buffer_load_dwordx4 v[172:175], v4, s[4:7], s58 offen offset:3072 sc1
    buffer_load_dwordx4 v[176:179], v3, s[4:7], s58 offen offset:0 sc1
    buffer_load_dwordx4 v[180:183], v3, s[4:7], s58 offen offset:1024 sc1
    buffer_load_dwordx4 v[184:187], v7, s[4:7], s58 offen offset:2048 sc1
    buffer_load_dwordx4 v[188:191], v7, s[4:7], s58 offen offset:3072 sc1
    s_waitcnt vmcnt(6)
    v_bitop3_b32 v208, v160, v161, v162 bitop3:0x96
    v_bitop3_b32 v208, v208, v163, v164 bitop3:0x96
    v_bitop3_b32 v208, v208, v165, v166 bitop3:0x96
    v_xor_b32 v208, v208, v167
    v_mov_b32 v209, v208
    s_waitcnt vmcnt(4)
    v_bitop3_b32 v210, v168, v169, v170 bitop3:0x96
    v_bitop3_b32 v210, v210, v171, v172 bitop3:0x96
    v_bitop3_b32 v210, v210, v173, v174 bitop3:0x96
    v_xor_b32 v210, v210, v175
    v_mov_b32 v211, v210
    s_waitcnt vmcnt(2)
    v_bitop3_b32 v212, v176, v177, v178 bitop3:0x96
    v_bitop3_b32 v212, v212, v179, v180 bitop3:0x96
    v_bitop3_b32 v212, v212, v181, v182 bitop3:0x96
    v_xor_b32 v212, v212, v183
    v_mov_b32 v213, v212
    s_waitcnt vmcnt(0)
    v_bitop3_b32 v214, v184, v185, v186 bitop3:0x96
    v_bitop3_b32 v214, v214, v187, v188 bitop3:0x96
    v_bitop3_b32 v214, v214, v189, v190 bitop3:0x96
    v_xor_b32 v214, v214, v191
    v_mov_b32 v215, v214
    v_permlane32_swap_b32 v208, v209
    v_permlane32_swap_b32 v210, v211
    v_permlane32_swap_b32 v212, v213
    v_permlane32_swap_b32 v214, v215
    v_bitop3_b32 v208, v208, v209, s33 bitop3:0x96
    v_bitop3_b32 v210, v210, v211, s33 bitop3:0x96
    v_bitop3_b32 v212, v212, v213, s33 bitop3:0x96
    v_bitop3_b32 v214, v214, v215, s33 bitop3:0x96
    v_or3_b32 v208, v208, v210, v212
    v_or_b32 v208, v208, v214
    v_cmp_ne_u32 vcc, 0, v208
    s_nop 0
    s_cbranch_vccnz L_b_kv
L_b_kv_t:
    s_waitcnt vmcnt(0)
L_b_kv_d:
    v_cndmask_b32 v166, v166, 0, s[98:99]
    v_cndmask_b32 v174, v174, 0, s[98:99]
    v_cndmask_b32 v182, v182, 0, s[98:99]
    v_cndmask_b32 v190, v190, 0, s[98:99]
    s_mov_b32 s55, 0x358637bd
    s_mul_i32 s56, s53, 7168
    s_add_u32 s56, s56, 32768
    v_add_u32 v5, s56, v14
    s_lshl_b32 s56, s53, 2
    s_add_u32 s56, s56, 159744
    v_mov_b32 v2, s56
    v_mov_b32 v3, s33
    v_mfma_f32_32x32x16_bf16 v[192:207], v[160:163], v[128:131], 0
    v_mfma_f32_32x32x16_bf16 v[192:207], v[164:167], v[132:135], v[192:207]
    v_mfma_f32_32x32x16_bf16 v[208:223], v[168:171], v[136:139], 0
    v_mfma_f32_32x32x16_bf16 v[208:223], v[172:175], v[140:143], v[208:223]
    v_mfma_f32_32x32x16_bf16 v[16:31], v[176:179], v[144:147], 0
    v_mfma_f32_32x32x16_bf16 v[16:31], v[180:183], v[148:151], v[16:31]
    v_mfma_f32_32x32x16_bf16 v[32:47], v[184:187], v[152:155], 0
    v_mfma_f32_32x32x16_bf16 v[32:47], v[188:191], v[156:159], v[32:47]
    s_nop 7
    v_cndmask_b32 v10, v220, v204, s[98:99]
    v_add_f32 v10, s55, v10
    v_rcp_f32 v10, v10
    v_cndmask_b32 v204, v204, v220, s[98:99]
    v_cndmask_b32 v205, v205, v221, s[98:99]
    v_cndmask_b32 v206, v206, v222, s[98:99]
    v_cndmask_b32 v207, v207, v223, s[98:99]
    v_mov_b32 v8, v10
    s_nop 1
    v_permlane32_swap_b32 v10, v8
    v_cndmask_b32 v6, v8, v10, s[98:99]
    v_pk_mul_f32 v[192:193], v[192:193], v[8:9] op_sel_hi:[1,0]
    v_pk_mul_f32 v[194:195], v[194:195], v[8:9] op_sel_hi:[1,0]
    v_pk_mul_f32 v[196:197], v[196:197], v[8:9] op_sel_hi:[1,0]
    v_pk_mul_f32 v[198:199], v[198:199], v[8:9] op_sel_hi:[1,0]
    v_pk_mul_f32 v[200:201], v[200:201], v[8:9] op_sel_hi:[1,0]
    v_pk_mul_f32 v[202:203], v[202:203], v[8:9] op_sel_hi:[1,0]
    v_pk_mul_f32 v[204:205], v[204:205], v[6:7] op_sel_hi:[1,0]
    v_pk_mul_f32 v[206:207], v[206:207], v[6:7] op_sel_hi:[1,0]
    v_pk_mul_f32 v[208:209], v[208:209], v[10:11] op_sel_hi:[1,0]
    v_pk_mul_f32 v[210:211], v[210:211], v[10:11] op_sel_hi:[1,0]
    v_pk_mul_f32 v[212:213], v[212:213], v[10:11] op_sel_hi:[1,0]
    v_pk_mul_f32 v[214:215], v[214:215], v[10:11] op_sel_hi:[1,0]
    v_pk_mul_f32 v[216:217], v[216:217], v[10:11] op_sel_hi:[1,0]
    v_pk_mul_f32 v[218:219], v[218:219], v[10:11] op_sel_hi:[1,0]
    v_cvt_pk_bf16_f32 v224, v192, v193
    v_cvt_pk_bf16_f32 v225, v194, v195
    v_cvt_pk_bf16_f32 v226, v196, v197
    v_cvt_pk_bf16_f32 v227, v198, v199
    v_cvt_pk_bf16_f32 v228, v200, v201
    v_cvt_pk_bf16_f32 v229, v202, v203
    v_cvt_pk_bf16_f32 v230, v204, v205
    v_cvt_pk_bf16_f32 v231, v206, v207
    v_cvt_pk_bf16_f32 v232, v208, v209
    v_cvt_pk_bf16_f32 v233, v210, v211
    v_cvt_pk_bf16_f32 v234, v212, v213
    v_cvt_pk_bf16_f32 v235, v214, v215
    v_cvt_pk_bf16_f32 v236, v216, v217
    v_cvt_pk_bf16_f32 v237, v218, v219
    ds_write_b128 v5, v[224:227] offset:0
    ds_write_b128 v5, v[228:231] offset:1024
    ds_write_b128 v5, v[232:235] offset:2048
    v_mfma_f32_32x32x16_bf16 v[192:207], v[160:163], v[64:67], 0
    v_mfma_f32_32x32x16_bf16 v[192:207], v[164:167], v[68:71], v[192:207]
    v_mfma_f32_32x32x16_bf16 v[208:223], v[168:171], v[72:75], 0
    v_mfma_f32_32x32x16_bf16 v[208:223], v[172:175], v[76:79], v[208:223]
    v_cndmask_b32 v10, v44, v28, s[98:99]
    v_add_f32 v10, s55, v10
    v_rcp_f32 v10, v10
    v_cndmask_b32 v28, v28, v44, s[98:99]
    v_cndmask_b32 v29, v29, v45, s[98:99]
    v_cndmask_b32 v30, v30, v46, s[98:99]
    v_cndmask_b32 v31, v31, v47, s[98:99]
    v_mov_b32 v8, v10
    s_nop 1
    v_permlane32_swap_b32 v10, v8
    v_cndmask_b32 v6, v8, v10, s[98:99]
    v_pk_mul_f32 v[16:17], v[16:17], v[8:9] op_sel_hi:[1,0]
    v_pk_mul_f32 v[18:19], v[18:19], v[8:9] op_sel_hi:[1,0]
    v_pk_mul_f32 v[20:21], v[20:21], v[8:9] op_sel_hi:[1,0]
    v_pk_mul_f32 v[22:23], v[22:23], v[8:9] op_sel_hi:[1,0]
    v_pk_mul_f32 v[24:25], v[24:25], v[8:9] op_sel_hi:[1,0]
    v_pk_mul_f32 v[26:27], v[26:27], v[8:9] op_sel_hi:[1,0]
    v_pk_mul_f32 v[28:29], v[28:29], v[6:7] op_sel_hi:[1,0]
    v_pk_mul_f32 v[30:31], v[30:31], v[6:7] op_sel_hi:[1,0]
    v_pk_mul_f32 v[32:33], v[32:33], v[10:11] op_sel_hi:[1,0]
    v_pk_mul_f32 v[34:35], v[34:35], v[10:11] op_sel_hi:[1,0]
    v_pk_mul_f32 v[36:37], v[36:37], v[10:11] op_sel_hi:[1,0]
    v_pk_mul_f32 v[38:39], v[38:39], v[10:11] op_sel_hi:[1,0]
    v_pk_mul_f32 v[40:41], v[40:41], v[10:11] op_sel_hi:[1,0]
    v_pk_mul_f32 v[42:43], v[42:43], v[10:11] op_sel_hi:[1,0]
    v_cvt_pk_bf16_f32 v238, v16, v17
    v_cvt_pk_bf16_f32 v239, v18, v19
    v_cvt_pk_bf16_f32 v240, v20, v21
    v_cvt_pk_bf16_f32 v241, v22, v23
    v_cvt_pk_bf16_f32 v242, v24, v25
    v_cvt_pk_bf16_f32 v243, v26, v27
    v_cvt_pk_bf16_f32 v244, v28, v29
    v_cvt_pk_bf16_f32 v245, v30, v31
    v_cvt_pk_bf16_f32 v246, v32, v33
    v_cvt_pk_bf16_f32 v247, v34, v35
    v_cvt_pk_bf16_f32 v248, v36, v37
    v_cvt_pk_bf16_f32 v249, v38, v39
    v_cvt_pk_bf16_f32 v250, v40, v41
    v_cvt_pk_bf16_f32 v251, v42, v43
    ds_write_b128 v5, v[236:239] offset:3072
    ds_write_b128 v5, v[240:243] offset:4096
    ds_write_b128 v5, v[244:247] offset:5120
    ds_write_b128 v5, v[248:251] offset:6144
    ds_write_b32 v2, v3 offset:0
    v_mfma_f32_32x32x16_bf16 v[16:31], v[176:179], v[80:83], 0
    v_mfma_f32_32x32x16_bf16 v[16:31], v[180:183], v[84:87], v[16:31]
    v_mfma_f32_32x32x16_bf16 v[32:47], v[184:187], v[88:91], 0
    v_mfma_f32_32x32x16_bf16 v[32:47], v[188:191], v[92:95], v[32:47]
    v_cndmask_b32 v10, v220, v204, s[98:99]
    v_add_f32 v10, s55, v10
    v_rcp_f32 v10, v10
    v_cndmask_b32 v204, v204, v220, s[98:99]
    v_cndmask_b32 v205, v205, v221, s[98:99]
    v_cndmask_b32 v206, v206, v222, s[98:99]
    v_cndmask_b32 v207, v207, v223, s[98:99]
    v_mov_b32 v8, v10
    s_nop 1
    v_permlane32_swap_b32 v10, v8
    v_cndmask_b32 v6, v8, v10, s[98:99]
    v_pk_mul_f32 v[192:193], v[192:193], v[8:9] op_sel_hi:[1,0]
    v_pk_mul_f32 v[194:195], v[194:195], v[8:9] op_sel_hi:[1,0]
    v_pk_mul_f32 v[196:197], v[196:197], v[8:9] op_sel_hi:[1,0]
    v_pk_mul_f32 v[198:199], v[198:199], v[8:9] op_sel_hi:[1,0]
    v_pk_mul_f32 v[200:201], v[200:201], v[8:9] op_sel_hi:[1,0]
    v_pk_mul_f32 v[202:203], v[202:203], v[8:9] op_sel_hi:[1,0]
    v_pk_mul_f32 v[204:205], v[204:205], v[6:7] op_sel_hi:[1,0]
    v_pk_mul_f32 v[206:207], v[206:207], v[6:7] op_sel_hi:[1,0]
    v_pk_mul_f32 v[208:209], v[208:209], v[10:11] op_sel_hi:[1,0]
    v_pk_mul_f32 v[210:211], v[210:211], v[10:11] op_sel_hi:[1,0]
    v_pk_mul_f32 v[212:213], v[212:213], v[10:11] op_sel_hi:[1,0]
    v_pk_mul_f32 v[214:215], v[214:215], v[10:11] op_sel_hi:[1,0]
    v_pk_mul_f32 v[216:217], v[216:217], v[10:11] op_sel_hi:[1,0]
    v_pk_mul_f32 v[218:219], v[218:219], v[10:11] op_sel_hi:[1,0]
    v_cvt_pk_bf16_f32 v96, v192, v193
    v_cvt_pk_bf16_f32 v97, v194, v195
    v_cvt_pk_bf16_f32 v98, v196, v197
    v_cvt_pk_bf16_f32 v99, v198, v199
    v_cvt_pk_bf16_f32 v100, v200, v201
    v_cvt_pk_bf16_f32 v101, v202, v203
    v_cvt_pk_bf16_f32 v102, v204, v205
    v_cvt_pk_bf16_f32 v103, v206, v207
    v_cvt_pk_bf16_f32 v104, v208, v209
    v_cvt_pk_bf16_f32 v105, v210, v211
    v_cvt_pk_bf16_f32 v106, v212, v213
    v_cvt_pk_bf16_f32 v107, v214, v215
    v_cvt_pk_bf16_f32 v108, v216, v217
    v_cvt_pk_bf16_f32 v109, v218, v219
    ds_write_b128 v5, v[96:99] offset:28672
    ds_write_b128 v5, v[100:103] offset:29696
    ds_write_b128 v5, v[104:107] offset:30720
    v_cndmask_b32 v10, v44, v28, s[98:99]
    v_add_f32 v10, s55, v10
    v_rcp_f32 v10, v10
    v_cndmask_b32 v28, v28, v44, s[98:99]
    v_cndmask_b32 v29, v29, v45, s[98:99]
    v_cndmask_b32 v30, v30, v46, s[98:99]
    v_cndmask_b32 v31, v31, v47, s[98:99]
    v_mov_b32 v8, v10
    s_nop 1
    v_permlane32_swap_b32 v10, v8
    v_cndmask_b32 v6, v8, v10, s[98:99]
    v_pk_mul_f32 v[16:17], v[16:17], v[8:9] op_sel_hi:[1,0]
    v_pk_mul_f32 v[18:19], v[18:19], v[8:9] op_sel_hi:[1,0]
    v_pk_mul_f32 v[20:21], v[20:21], v[8:9] op_sel_hi:[1,0]
    v_pk_mul_f32 v[22:23], v[22:23], v[8:9] op_sel_hi:[1,0]
    v_pk_mul_f32 v[24:25], v[24:25], v[8:9] op_sel_hi:[1,0]
    v_pk_mul_f32 v[26:27], v[26:27], v[8:9] op_sel_hi:[1,0]
    v_pk_mul_f32 v[28:29], v[28:29], v[6:7] op_sel_hi:[1,0]
    v_pk_mul_f32 v[30:31], v[30:31], v[6:7] op_sel_hi:[1,0]
    v_pk_mul_f32 v[32:33], v[32:33], v[10:11] op_sel_hi:[1,0]
    v_pk_mul_f32 v[34:35], v[34:35], v[10:11] op_sel_hi:[1,0]
    v_pk_mul_f32 v[36:37], v[36:37], v[10:11] op_sel_hi:[1,0]
    v_pk_mul_f32 v[38:39], v[38:39], v[10:11] op_sel_hi:[1,0]
    v_pk_mul_f32 v[40:41], v[40:41], v[10:11] op_sel_hi:[1,0]
    v_pk_mul_f32 v[42:43], v[42:43], v[10:11] op_sel_hi:[1,0]
    v_cvt_pk_bf16_f32 v110, v16, v17
    v_cvt_pk_bf16_f32 v111, v18, v19
    v_cvt_pk_bf16_f32 v112, v20, v21
    v_cvt_pk_bf16_f32 v113, v22, v23
    v_cvt_pk_bf16_f32 v114, v24, v25
    v_cvt_pk_bf16_f32 v115, v26, v27
    v_cvt_pk_bf16_f32 v116, v28, v29
    v_cvt_pk_bf16_f32 v117, v30, v31
    v_cvt_pk_bf16_f32 v118, v32, v33
    v_cvt_pk_bf16_f32 v119, v34, v35
    v_cvt_pk_bf16_f32 v120, v36, v37
    v_cvt_pk_bf16_f32 v121, v38, v39
    v_cvt_pk_bf16_f32 v122, v40, v41
    v_cvt_pk_bf16_f32 v123, v42, v43
    ds_write_b128 v5, v[108:111] offset:31744
    ds_write_b128 v5, v[112:115] offset:32768
    ds_write_b128 v5, v[116:119] offset:33792
    ds_write_b128 v5, v[120:123] offset:34816
    ds_write_b32 v2, v3 offset:16
    s_waitcnt lgkmcnt(0)
    s_lshl_b32 s90, s3, 3
    s_or_b32 s90, s90, s30
    s_cmp_eq_u32 s90, 4
    s_cbranch_scc0 L_b_fin
    buffer_wbl2 sc1
    s_branch L_b_fin
L_b_lo:
    s_setprio 1
    s_add_u32 s95, s94, 0
    buffer_load_dwordx4 v[16:19], v14, s[4:7], s95 offen offset:0 sc1
    buffer_load_dwordx4 v[20:23], v14, s[4:7], s95 offen offset:1024 sc1
    buffer_load_dword v232, v13, s[4:7], s95 offen offset:2048 sc1
    s_add_u32 s95, s94, 2304
    buffer_load_dwordx4 v[24:27], v14, s[4:7], s95 offen offset:0 sc1
    buffer_load_dwordx4 v[28:31], v14, s[4:7], s95 offen offset:1024 sc1
    buffer_load_dword v233, v13, s[4:7], s95 offen offset:2048 sc1
    s_add_u32 s95, s94, 4608
    buffer_load_dwordx4 v[32:35], v14, s[4:7], s95 offen offset:0 sc1
    buffer_load_dwordx4 v[36:39], v14, s[4:7], s95 offen offset:1024 sc1
    buffer_load_dword v234, v13, s[4:7], s95 offen offset:2048 sc1
    s_add_u32 s95, s94, 6912
    buffer_load_dwordx4 v[40:43], v14, s[4:7], s95 offen offset:0 sc1
    buffer_load_dwordx4 v[44:47], v14, s[4:7], s95 offen offset:1024 sc1
    buffer_load_dword v235, v13, s[4:7], s95 offen offset:2048 sc1
    s_add_u32 s95, s94, 9216
    buffer_load_dwordx4 v[48:51], v14, s[4:7], s95 offen offset:0 sc1
    buffer_load_dwordx4 v[52:55], v14, s[4:7], s95 offen offset:1024 sc1
    buffer_load_dword v236, v13, s[4:7], s95 offen offset:2048 sc1
    s_waitcnt vmcnt(12)
    v_bitop3_b32 v232, v232, v16, v17 bitop3:0x96
    v_bitop3_b32 v232, v232, v18, v19 bitop3:0x96
    v_bitop3_b32 v232, v232, v20, v21 bitop3:0x96
    v_bitop3_b32 v232, v232, v22, v23 bitop3:0x96
    v_xor_b32 v232, s33, v232
    s_add_u32 s95, s94, 11520
    buffer_load_dwordx4 v[56:59], v14, s[4:7], s95 offen offset:0 sc1
    buffer_load_dwordx4 v[60:63], v14, s[4:7], s95 offen offset:1024 sc1
    buffer_load_dword v237, v13, s[4:7], s95 offen offset:2048 sc1
    s_waitcnt vmcnt(12)
    v_bitop3_b32 v233, v233, v24, v25 bitop3:0x96
    v_bitop3_b32 v233, v233, v26, v27 bitop3:0x96
    v_bitop3_b32 v233, v233, v28, v29 bitop3:0x96
    v_bitop3_b32 v233, v233, v30, v31 bitop3:0x96
    v_xor_b32 v233, s33, v233
    s_add_u32 s95, s94, 13824
    buffer_load_dwordx4 v[64:67], v14, s[4:7], s95 offen offset:0 sc1
    buffer_load_dwordx4 v[68:71], v14, s[4:7], s95 offen offset:1024 sc1
    buffer_load_dword v238, v13, s[4:7], s95 offen offset:2048 sc1
    s_waitcnt vmcnt(12)
    v_bitop3_b32 v234, v234, v32, v33 bitop3:0x96
    v_bitop3_b32 v234, v234, v34, v35 bitop3:0x96
    v_bitop3_b32 v234, v234, v36, v37 bitop3:0x96
    v_bitop3_b32 v234, v234, v38, v39 bitop3:0x96
    v_xor_b32 v234, s33, v234
    s_add_u32 s95, s94, 16128
    buffer_load_dwordx4 v[72:75], v14, s[4:7], s95 offen offset:0 sc1
    buffer_load_dwordx4 v[76:79], v14, s[4:7], s95 offen offset:1024 sc1
    buffer_load_dword v239, v13, s[4:7], s95 offen offset:2048 sc1
    s_waitcnt vmcnt(12)
    v_bitop3_b32 v235, v235, v40, v41 bitop3:0x96
    v_bitop3_b32 v235, v235, v42, v43 bitop3:0x96
    v_bitop3_b32 v235, v235, v44, v45 bitop3:0x96
    v_bitop3_b32 v235, v235, v46, v47 bitop3:0x96
    v_xor_b32 v235, s33, v235
    s_add_u32 s95, s94, 18432
    buffer_load_dwordx4 v[80:83], v14, s[4:7], s95 offen offset:0 sc1
    buffer_load_dwordx4 v[84:87], v14, s[4:7], s95 offen offset:1024 sc1
    buffer_load_dword v240, v13, s[4:7], s95 offen offset:2048 sc1
    s_waitcnt vmcnt(12)
    v_bitop3_b32 v236, v236, v48, v49 bitop3:0x96
    v_bitop3_b32 v236, v236, v50, v51 bitop3:0x96
    v_bitop3_b32 v236, v236, v52, v53 bitop3:0x96
    v_bitop3_b32 v236, v236, v54, v55 bitop3:0x96
    v_xor_b32 v236, s33, v236
    s_add_u32 s95, s94, 20736
    buffer_load_dwordx4 v[88:91], v14, s[4:7], s95 offen offset:0 sc1
    buffer_load_dwordx4 v[92:95], v14, s[4:7], s95 offen offset:1024 sc1
    buffer_load_dword v241, v13, s[4:7], s95 offen offset:2048 sc1
    s_waitcnt vmcnt(12)
    v_bitop3_b32 v237, v237, v56, v57 bitop3:0x96
    v_bitop3_b32 v237, v237, v58, v59 bitop3:0x96
    v_bitop3_b32 v237, v237, v60, v61 bitop3:0x96
    v_bitop3_b32 v237, v237, v62, v63 bitop3:0x96
    v_xor_b32 v237, s33, v237
    s_add_u32 s95, s94, 23040
    buffer_load_dwordx4 v[96:99], v14, s[4:7], s95 offen offset:0 sc1
    buffer_load_dwordx4 v[100:103], v14, s[4:7], s95 offen offset:1024 sc1
    buffer_load_dword v242, v13, s[4:7], s95 offen offset:2048 sc1
    s_waitcnt vmcnt(12)
    v_bitop3_b32 v238, v238, v64, v65 bitop3:0x96
    v_bitop3_b32 v238, v238, v66, v67 bitop3:0x96
    v_bitop3_b32 v238, v238, v68, v69 bitop3:0x96
    v_bitop3_b32 v238, v238, v70, v71 bitop3:0x96
    v_xor_b32 v238, s33, v238
    s_waitcnt vmcnt(9)
    v_bitop3_b32 v239, v239, v72, v73 bitop3:0x96
    v_bitop3_b32 v239, v239, v74, v75 bitop3:0x96
    v_bitop3_b32 v239, v239, v76, v77 bitop3:0x96
    v_bitop3_b32 v239, v239, v78, v79 bitop3:0x96
    v_xor_b32 v239, s33, v239
    s_waitcnt vmcnt(6)
    v_bitop3_b32 v240, v240, v80, v81 bitop3:0x96
    v_bitop3_b32 v240, v240, v82, v83 bitop3:0x96
    v_bitop3_b32 v240, v240, v84, v85 bitop3:0x96
    v_bitop3_b32 v240, v240, v86, v87 bitop3:0x96
    v_xor_b32 v240, s33, v240
    s_waitcnt vmcnt(3)
    v_bitop3_b32 v241, v241, v88, v89 bitop3:0x96
    v_bitop3_b32 v241, v241, v90, v91 bitop3:0x96
    v_bitop3_b32 v241, v241, v92, v93 bitop3:0x96
    v_bitop3_b32 v241, v241, v94, v95 bitop3:0x96
    v_xor_b32 v241, s33, v241
    s_waitcnt vmcnt(0)
    v_bitop3_b32 v242, v242, v96, v97 bitop3:0x96
    v_bitop3_b32 v242, v242, v98, v99 bitop3:0x96
    v_bitop3_b32 v242, v242, v100, v101 bitop3:0x96
    v_bitop3_b32 v242, v242, v102, v103 bitop3:0x96
    v_xor_b32 v242, s33, v242
    s_setprio 3
    s_getreg_b32 s56, hwreg(HW_REG_XCC_ID)
    s_and_b32 s56, s56, 15
    s_lshl_b32 s56, s56, 4
    s_xor_b32 s56, s56, s33
    v_cmp_ne_u32 vcc, s56, v252
    s_nop 0
    s_cmp_eq_u64 vcc, 0
    s_cselect_b32 s47, 1, 0
    v_lshrrev_b32 v208, 5, v1
    v_lshlrev_b32 v208, 11, v208
    v_and_b32 v209, 31, v1
    v_lshl_add_u32 v208, v209, 4, v208
    s_lshl_b32 s56, s3, 15
    s_lshl_b32 s55, s53, 9
    s_add_u32 s56, s56, s55
    v_and_b32 v15, 1, v1
    v_lshlrev_b32 v15, 10, v15
    v_bfe_u32 v209, v1, 1, 1
    v_lshl_add_u32 v15, v209, 9, v15
    v_bfe_u32 v209, v1, 2, 3
    v_lshl_add_u32 v15, v209, 4, v15
    v_lshrrev_b32 v209, 5, v1
    v_lshl_add_u32 v15, v209, 3, v15
    s_lshl_b32 s58, s31, 15
    s_lshl_b32 s55, s3, 11
    s_add_u32 s58, s58, s55
    s_lshl_b32 s55, s53, 7
    s_add_u32 s58, s58, s55
    s_add_u32 s58, s58, 524288
    v_mov_b32 v220, 0x00003f80
    v_mov_b32 v221, 0x3f800000
    v_and_b32 v209, 0x23, v1
    v_cmp_eq_u32 vcc, 0x23, v209
    s_nop 0
    s_mov_b64 s[44:45], vcc
    s_mov_b32 s91, 0
L_b_rpoll:
    s_add_u32 s55, s56, 0
    buffer_load_dwordx4 v[128:131], v208, s[4:7], s55 offen sc1
    s_add_u32 s55, s56, 4096
    buffer_load_dwordx4 v[132:135], v208, s[4:7], s55 offen sc1
    s_add_u32 s55, s56, 8192
    buffer_load_dwordx4 v[136:139], v208, s[4:7], s55 offen sc1
    s_add_u32 s55, s56, 12288
    buffer_load_dwordx4 v[140:143], v208, s[4:7], s55 offen sc1
    s_add_u32 s55, s56, 16384
    buffer_load_dwordx4 v[144:147], v208, s[4:7], s55 offen sc1
    s_add_u32 s55, s56, 20480
    buffer_load_dwordx4 v[148:151], v208, s[4:7], s55 offen sc1
    s_add_u32 s55, s56, 24576
    buffer_load_dwordx4 v[152:155], v208, s[4:7], s55 offen sc1
    s_add_u32 s55, s56, 28672
    buffer_load_dwordx4 v[156:159], v208, s[4:7], s55 offen sc1
    s_add_u32 s91, s91, 1
    s_cmp_gt_u32 s91, 0x4000
    s_cbranch_scc1 L_b_rdone
    s_waitcnt vmcnt(7)
    v_bitop3_b32 v210, v128, v129, v130 bitop3:0x96
    v_xor_b32 v210, v210, v131
    v_dot2_f32_bf16 v160, v128, v220, 0
    v_dot2_f32_bf16 v161, v128, v221, 0
    v_dot2_f32_bf16 v162, v129, v220, 0
    v_dot2_f32_bf16 v163, v129, v221, 0
    v_dot2_f32_bf16 v164, v130, v220, 0
    v_dot2_f32_bf16 v165, v130, v221, 0
    v_dot2_f32_bf16 v166, v131, v220, 0
    v_dot2_f32_bf16 v167, v131, v221, 0
    s_waitcnt vmcnt(6)
    v_bitop3_b32 v211, v132, v133, v134 bitop3:0x96
    v_xor_b32 v211, v211, v135
    v_dot2_f32_bf16 v160, v132, v220, v160
    v_dot2_f32_bf16 v161, v132, v221, v161
    v_dot2_f32_bf16 v162, v133, v220, v162
    v_dot2_f32_bf16 v163, v133, v221, v163
    v_dot2_f32_bf16 v164, v134, v220, v164
    v_dot2_f32_bf16 v165, v134, v221, v165
    v_dot2_f32_bf16 v166, v135, v220, v166
    v_dot2_f32_bf16 v167, v135, v221, v167
    s_waitcnt vmcnt(5)
    v_bitop3_b32 v212, v136, v137, v138 bitop3:0x96
    v_xor_b32 v212, v212, v139
    v_dot2_f32_bf16 v160, v136, v220, v160
    v_dot2_f32_bf16 v161, v136, v221, v161
    v_dot2_f32_bf16 v162, v137, v220, v162
    v_dot2_f32_bf16 v163, v137, v221, v163
    v_dot2_f32_bf16 v164, v138, v220, v164
    v_dot2_f32_bf16 v165, v138, v221, v165
    v_dot2_f32_bf16 v166, v139, v220, v166
    v_dot2_f32_bf16 v167, v139, v221, v167
    s_waitcnt vmcnt(4)
    v_bitop3_b32 v213, v140, v141, v142 bitop3:0x96
    v_xor_b32 v213, v213, v143
    v_dot2_f32_bf16 v160, v140, v220, v160
    v_dot2_f32_bf16 v161, v140, v221, v161
    v_dot2_f32_bf16 v162, v141, v220, v162
    v_dot2_f32_bf16 v163, v141, v221, v163
    v_dot2_f32_bf16 v164, v142, v220, v164
    v_dot2_f32_bf16 v165, v142, v221, v165
    v_dot2_f32_bf16 v166, v143, v220, v166
    v_dot2_f32_bf16 v167, v143, v221, v167
    s_waitcnt vmcnt(3)
    v_bitop3_b32 v214, v144, v145, v146 bitop3:0x96
    v_xor_b32 v214, v214, v147
    v_dot2_f32_bf16 v160, v144, v220, v160
    v_dot2_f32_bf16 v161, v144, v221, v161
    v_dot2_f32_bf16 v162, v145, v220, v162
    v_dot2_f32_bf16 v163, v145, v221, v163
    v_dot2_f32_bf16 v164, v146, v220, v164
    v_dot2_f32_bf16 v165, v146, v221, v165
    v_dot2_f32_bf16 v166, v147, v220, v166
    v_dot2_f32_bf16 v167, v147, v221, v167
    s_waitcnt vmcnt(2)
    v_bitop3_b32 v215, v148, v149, v150 bitop3:0x96
    v_xor_b32 v215, v215, v151
    v_dot2_f32_bf16 v160, v148, v220, v160
    v_dot2_f32_bf16 v161, v148, v221, v161
    v_dot2_f32_bf16 v162, v149, v220, v162
    v_dot2_f32_bf16 v163, v149, v221, v163
    v_dot2_f32_bf16 v164, v150, v220, v164
    v_dot2_f32_bf16 v165, v150, v221, v165
    v_dot2_f32_bf16 v166, v151, v220, v166
    v_dot2_f32_bf16 v167, v151, v221, v167
    s_waitcnt vmcnt(1)
    v_bitop3_b32 v216, v152, v153, v154 bitop3:0x96
    v_xor_b32 v216, v216, v155
    v_dot2_f32_bf16 v160, v152, v220, v160
    v_dot2_f32_bf16 v161, v152, v221, v161
    v_dot2_f32_bf16 v162, v153, v220, v162
    v_dot2_f32_bf16 v163, v153, v221, v163
    v_dot2_f32_bf16 v164, v154, v220, v164
    v_dot2_f32_bf16 v165, v154, v221, v165
    v_dot2_f32_bf16 v166, v155, v220, v166
    v_dot2_f32_bf16 v167, v155, v221, v167
    s_waitcnt vmcnt(0)
    v_bitop3_b32 v217, v156, v157, v158 bitop3:0x96
    v_xor_b32 v217, v217, v159
    v_dot2_f32_bf16 v160, v156, v220, v160
    v_dot2_f32_bf16 v161, v156, v221, v161
    v_dot2_f32_bf16 v162, v157, v220, v162
    v_dot2_f32_bf16 v163, v157, v221, v163
    v_dot2_f32_bf16 v164, v158, v220, v164
    v_dot2_f32_bf16 v165, v158, v221, v165
    v_dot2_f32_bf16 v166, v159, v220, v166
    v_dot2_f32_bf16 v167, v159, v221, v167
    v_xor_b32_dpp v210, v210, v210 quad_perm:[1,0,3,2] row_mask:0xf bank_mask:0xf
    v_xor_b32_dpp v211, v211, v211 quad_perm:[1,0,3,2] row_mask:0xf bank_mask:0xf
    v_xor_b32_dpp v212, v212, v212 quad_perm:[1,0,3,2] row_mask:0xf bank_mask:0xf
    v_xor_b32_dpp v213, v213, v213 quad_perm:[1,0,3,2] row_mask:0xf bank_mask:0xf
    v_xor_b32_dpp v214, v214, v214 quad_perm:[1,0,3,2] row_mask:0xf bank_mask:0xf
    v_xor_b32_dpp v215, v215, v215 quad_perm:[1,0,3,2] row_mask:0xf bank_mask:0xf
    v_xor_b32_dpp v216, v216, v216 quad_perm:[1,0,3,2] row_mask:0xf bank_mask:0xf
    v_xor_b32_dpp v217, v217, v217 quad_perm:[1,0,3,2] row_mask:0xf bank_mask:0xf
    v_xor_b32_dpp v210, v210, v210 quad_perm:[2,3,0,1] row_mask:0xf bank_mask:0xf
    v_xor_b32_dpp v211, v211, v211 quad_perm:[2,3,0,1] row_mask:0xf bank_mask:0xf
    v_xor_b32_dpp v212, v212, v212 quad_perm:[2,3,0,1] row_mask:0xf bank_mask:0xf
    v_xor_b32_dpp v213, v213, v213 quad_perm:[2,3,0,1] row_mask:0xf bank_mask:0xf
    v_xor_b32_dpp v214, v214, v214 quad_perm:[2,3,0,1] row_mask:0xf bank_mask:0xf
    v_xor_b32_dpp v215, v215, v215 quad_perm:[2,3,0,1] row_mask:0xf bank_mask:0xf
    v_xor_b32_dpp v216, v216, v216 quad_perm:[2,3,0,1] row_mask:0xf bank_mask:0xf
    v_xor_b32_dpp v217, v217, v217 quad_perm:[2,3,0,1] row_mask:0xf bank_mask:0xf
    v_xor_b32 v210, s33, v210
    v_xor_b32 v211, s33, v211
    v_xor_b32 v212, s33, v212
    v_xor_b32 v213, s33, v213
    v_xor_b32 v214, s33, v214
    v_xor_b32 v215, s33, v215
    v_xor_b32 v216, s33, v216
    v_xor_b32 v217, s33, v217
    v_or3_b32 v210, v210, v211, v212
    v_or3_b32 v213, v213, v214, v215
    v_or3_b32 v210, v210, v216, v217
    v_or_b32 v210, v210, v213
    v_cmp_ne_u32 vcc, 0, v210
    s_nop 0
    s_cbranch_vccnz L_b_rpoll
L_b_rdone:
    s_waitcnt vmcnt(0)
    v_permlane32_swap_b32 v160, v164
    v_permlane32_swap_b32 v161, v165
    v_permlane32_swap_b32 v162, v166
    v_permlane32_swap_b32 v163, v167
    v_pk_add_f32 v[160:161], v[160:161], v[164:165]
    v_pk_add_f32 v[162:163], v[162:163], v[166:167]
    v_cvt_pk_bf16_f32 v168, v160, v161
    v_cvt_pk_bf16_f32 v169, v162, v163
    v_cndmask_b32 v168, v168, 0, s[44:45]
    v_cndmask_b32 v169, v169, 0, s[44:45]
    v_xor_b32 v162, v168, v169
    s_nop 1
    v_xor_b32_dpp v162, v162, v162 quad_perm:[1,0,3,2] row_mask:0xf bank_mask:0xf
    s_nop 1
    v_xor_b32_dpp v162, v162, v162 quad_perm:[2,3,0,1] row_mask:0xf bank_mask:0xf
    v_mov_b32 v163, v162
    s_nop 1
    v_permlane32_swap_b32 v162, v163
    v_bitop3_b32 v162, v162, v163, s33 bitop3:0x96
    v_cndmask_b32 v168, v168, v162, s[44:45]
    buffer_store_dwordx2 v[168:169], v15, s[4:7], s58 offen
    s_cmp_eq_u32 s47, 1
    s_cbranch_scc1 L_b_nored
    s_add_u32 s58, s58, 16777216
    buffer_store_dwordx2 v[168:169], v15, s[4:7], s58 offen sc1
L_b_nored:
    s_waitcnt vmcnt(0)
    s_lshl_b32 s56, s53, 2
    s_add_u32 s56, s56, 159776
    v_mov_b32 v2, s56
    v_mov_b32 v3, s33
    ds_write_b32 v2, v3
    s_setprio 0
    s_cmp_eq_u32 s89, 0
    s_cbranch_scc0 L_b_fin
    s_mov_b32 s90, 0
    s_add_u32 s95, s94, 25344
    buffer_load_dwordx4 v[104:107], v14, s[4:7], s95 offen offset:0 sc1
    buffer_load_dwordx4 v[108:111], v14, s[4:7], s95 offen offset:1024 sc1
    buffer_load_dword v243, v13, s[4:7], s95 offen offset:2048 sc1
    s_add_u32 s95, s94, 27648
    buffer_load_dwordx4 v[112:115], v14, s[4:7], s95 offen offset:0 sc1
    buffer_load_dwordx4 v[116:119], v14, s[4:7], s95 offen offset:1024 sc1
    buffer_load_dword v244, v13, s[4:7], s95 offen offset:2048 sc1
    s_add_u32 s95, s94, 29952
    buffer_load_dwordx4 v[120:123], v14, s[4:7], s95 offen offset:0 sc1
    buffer_load_dwordx4 v[124:127], v14, s[4:7], s95 offen offset:1024 sc1
    buffer_load_dword v245, v13, s[4:7], s95 offen offset:2048 sc1
    s_waitcnt vmcnt(6)
    v_bitop3_b32 v243, v243, v104, v105 bitop3:0x96
    v_bitop3_b32 v243, v243, v106, v107 bitop3:0x96
    v_bitop3_b32 v243, v243, v108, v109 bitop3:0x96
    v_bitop3_b32 v243, v243, v110, v111 bitop3:0x96
    v_xor_b32 v243, s33, v243
    s_waitcnt vmcnt(3)
    v_bitop3_b32 v244, v244, v112, v113 bitop3:0x96
    v_bitop3_b32 v244, v244, v114, v115 bitop3:0x96
    v_bitop3_b32 v244, v244, v116, v117 bitop3:0x96
    v_bitop3_b32 v244, v244, v118, v119 bitop3:0x96
    v_xor_b32 v244, s33, v244
    s_waitcnt vmcnt(0)
    v_bitop3_b32 v245, v245, v120, v121 bitop3:0x96
    v_bitop3_b32 v245, v245, v122, v123 bitop3:0x96
    v_bitop3_b32 v245, v245, v124, v125 bitop3:0x96
    v_bitop3_b32 v245, v245, v126, v127 bitop3:0x96
    v_xor_b32 v245, s33, v245
    s_branch L_b_wochk
L_b_wopoll:
    s_add_u32 s90, s90, 1
    s_cmp_gt_u32 s90, 0x1000
    s_cbranch_scc1 L_b_wod
    s_add_u32 s95, s94, 0
    buffer_load_dwordx4 v[16:19], v14, s[4:7], s95 offen offset:0 sc1
    buffer_load_dwordx4 v[20:23], v14, s[4:7], s95 offen offset:1024 sc1
    buffer_load_dword v232, v13, s[4:7], s95 offen offset:2048 sc1
    s_add_u32 s95, s94, 2304
    buffer_load_dwordx4 v[24:27], v14, s[4:7], s95 offen offset:0 sc1
    buffer_load_dwordx4 v[28:31], v14, s[4:7], s95 offen offset:1024 sc1
    buffer_load_dword v233, v13, s[4:7], s95 offen offset:2048 sc1
    s_add_u32 s95, s94, 4608
    buffer_load_dwordx4 v[32:35], v14, s[4:7], s95 offen offset:0 sc1
    buffer_load_dwordx4 v[36:39], v14, s[4:7], s95 offen offset:1024 sc1
    buffer_load_dword v234, v13, s[4:7], s95 offen offset:2048 sc1
    s_add_u32 s95, s94, 6912
    buffer_load_dwordx4 v[40:43], v14, s[4:7], s95 offen offset:0 sc1
    buffer_load_dwordx4 v[44:47], v14, s[4:7], s95 offen offset:1024 sc1
    buffer_load_dword v235, v13, s[4:7], s95 offen offset:2048 sc1
    s_add_u32 s95, s94, 9216
    buffer_load_dwordx4 v[48:51], v14, s[4:7], s95 offen offset:0 sc1
    buffer_load_dwordx4 v[52:55], v14, s[4:7], s95 offen offset:1024 sc1
    buffer_load_dword v236, v13, s[4:7], s95 offen offset:2048 sc1
    s_waitcnt vmcnt(12)
    v_bitop3_b32 v232, v232, v16, v17 bitop3:0x96
    v_bitop3_b32 v232, v232, v18, v19 bitop3:0x96
    v_bitop3_b32 v232, v232, v20, v21 bitop3:0x96
    v_bitop3_b32 v232, v232, v22, v23 bitop3:0x96
    v_xor_b32 v232, s33, v232
    s_add_u32 s95, s94, 11520
    buffer_load_dwordx4 v[56:59], v14, s[4:7], s95 offen offset:0 sc1
    buffer_load_dwordx4 v[60:63], v14, s[4:7], s95 offen offset:1024 sc1
    buffer_load_dword v237, v13, s[4:7], s95 offen offset:2048 sc1
    s_waitcnt vmcnt(12)
    v_bitop3_b32 v233, v233, v24, v25 bitop3:0x96
    v_bitop3_b32 v233, v233, v26, v27 bitop3:0x96
    v_bitop3_b32 v233, v233, v28, v29 bitop3:0x96
    v_bitop3_b32 v233, v233, v30, v31 bitop3:0x96
    v_xor_b32 v233, s33, v233
    s_add_u32 s95, s94, 13824
    buffer_load_dwordx4 v[64:67], v14, s[4:7], s95 offen offset:0 sc1
    buffer_load_dwordx4 v[68:71], v14, s[4:7], s95 offen offset:1024 sc1
    buffer_load_dword v238, v13, s[4:7], s95 offen offset:2048 sc1
    s_waitcnt vmcnt(12)
    v_bitop3_b32 v234, v234, v32, v33 bitop3:0x96
    v_bitop3_b32 v234, v234, v34, v35 bitop3:0x96
    v_bitop3_b32 v234, v234, v36, v37 bitop3:0x96
    v_bitop3_b32 v234, v234, v38, v39 bitop3:0x96
    v_xor_b32 v234, s33, v234
    s_add_u32 s95, s94, 16128
    buffer_load_dwordx4 v[72:75], v14, s[4:7], s95 offen offset:0 sc1
    buffer_load_dwordx4 v[76:79], v14, s[4:7], s95 offen offset:1024 sc1
    buffer_load_dword v239, v13, s[4:7], s95 offen offset:2048 sc1
    s_waitcnt vmcnt(12)
    v_bitop3_b32 v235, v235, v40, v41 bitop3:0x96
    v_bitop3_b32 v235, v235, v42, v43 bitop3:0x96
    v_bitop3_b32 v235, v235, v44, v45 bitop3:0x96
    v_bitop3_b32 v235, v235, v46, v47 bitop3:0x96
    v_xor_b32 v235, s33, v235
    s_add_u32 s95, s94, 18432
    buffer_load_dwordx4 v[80:83], v14, s[4:7], s95 offen offset:0 sc1
    buffer_load_dwordx4 v[84:87], v14, s[4:7], s95 offen offset:1024 sc1
    buffer_load_dword v240, v13, s[4:7], s95 offen offset:2048 sc1
    s_waitcnt vmcnt(12)
    v_bitop3_b32 v236, v236, v48, v49 bitop3:0x96
    v_bitop3_b32 v236, v236, v50, v51 bitop3:0x96
    v_bitop3_b32 v236, v236, v52, v53 bitop3:0x96
    v_bitop3_b32 v236, v236, v54, v55 bitop3:0x96
    v_xor_b32 v236, s33, v236
    s_add_u32 s95, s94, 20736
    buffer_load_dwordx4 v[88:91], v14, s[4:7], s95 offen offset:0 sc1
    buffer_load_dwordx4 v[92:95], v14, s[4:7], s95 offen offset:1024 sc1
    buffer_load_dword v241, v13, s[4:7], s95 offen offset:2048 sc1
    s_waitcnt vmcnt(12)
    v_bitop3_b32 v237, v237, v56, v57 bitop3:0x96
    v_bitop3_b32 v237, v237, v58, v59 bitop3:0x96
    v_bitop3_b32 v237, v237, v60, v61 bitop3:0x96
    v_bitop3_b32 v237, v237, v62, v63 bitop3:0x96
    v_xor_b32 v237, s33, v237
    s_add_u32 s95, s94, 23040
    buffer_load_dwordx4 v[96:99], v14, s[4:7], s95 offen offset:0 sc1
    buffer_load_dwordx4 v[100:103], v14, s[4:7], s95 offen offset:1024 sc1
    buffer_load_dword v242, v13, s[4:7], s95 offen offset:2048 sc1
    s_waitcnt vmcnt(12)
    v_bitop3_b32 v238, v238, v64, v65 bitop3:0x96
    v_bitop3_b32 v238, v238, v66, v67 bitop3:0x96
    v_bitop3_b32 v238, v238, v68, v69 bitop3:0x96
    v_bitop3_b32 v238, v238, v70, v71 bitop3:0x96
    v_xor_b32 v238, s33, v238
    s_add_u32 s95, s94, 25344
    buffer_load_dwordx4 v[104:107], v14, s[4:7], s95 offen offset:0 sc1
    buffer_load_dwordx4 v[108:111], v14, s[4:7], s95 offen offset:1024 sc1
    buffer_load_dword v243, v13, s[4:7], s95 offen offset:2048 sc1
    s_waitcnt vmcnt(12)
    v_bitop3_b32 v239, v239, v72, v73 bitop3:0x96
    v_bitop3_b32 v239, v239, v74, v75 bitop3:0x96
    v_bitop3_b32 v239, v239, v76, v77 bitop3:0x96
    v_bitop3_b32 v239, v239, v78, v79 bitop3:0x96
    v_xor_b32 v239, s33, v239
    s_add_u32 s95, s94, 27648
    buffer_load_dwordx4 v[112:115], v14, s[4:7], s95 offen offset:0 sc1
    buffer_load_dwordx4 v[116:119], v14, s[4:7], s95 offen offset:1024 sc1
    buffer_load_dword v244, v13, s[4:7], s95 offen offset:2048 sc1
    s_waitcnt vmcnt(12)
    v_bitop3_b32 v240, v240, v80, v81 bitop3:0x96
    v_bitop3_b32 v240, v240, v82, v83 bitop3:0x96
    v_bitop3_b32 v240, v240, v84, v85 bitop3:0x96
    v_bitop3_b32 v240, v240, v86, v87 bitop3:0x96
    v_xor_b32 v240, s33, v240
    s_add_u32 s95, s94, 29952
    buffer_load_dwordx4 v[120:123], v14, s[4:7], s95 offen offset:0 sc1
    buffer_load_dwordx4 v[124:127], v14, s[4:7], s95 offen offset:1024 sc1
    buffer_load_dword v245, v13, s[4:7], s95 offen offset:2048 sc1
    s_waitcnt vmcnt(12)
    v_bitop3_b32 v241, v241, v88, v89 bitop3:0x96
    v_bitop3_b32 v241, v241, v90, v91 bitop3:0x96
    v_bitop3_b32 v241, v241, v92, v93 bitop3:0x96
    v_bitop3_b32 v241, v241, v94, v95 bitop3:0x96
    v_xor_b32 v241, s33, v241
    s_waitcnt vmcnt(9)
    v_bitop3_b32 v242, v242, v96, v97 bitop3:0x96
    v_bitop3_b32 v242, v242, v98, v99 bitop3:0x96
    v_bitop3_b32 v242, v242, v100, v101 bitop3:0x96
    v_bitop3_b32 v242, v242, v102, v103 bitop3:0x96
    v_xor_b32 v242, s33, v242
    s_waitcnt vmcnt(6)
    v_bitop3_b32 v243, v243, v104, v105 bitop3:0x96
    v_bitop3_b32 v243, v243, v106, v107 bitop3:0x96
    v_bitop3_b32 v243, v243, v108, v109 bitop3:0x96
    v_bitop3_b32 v243, v243, v110, v111 bitop3:0x96
    v_xor_b32 v243, s33, v243
    s_waitcnt vmcnt(3)
    v_bitop3_b32 v244, v244, v112, v113 bitop3:0x96
    v_bitop3_b32 v244, v244, v114, v115 bitop3:0x96
    v_bitop3_b32 v244, v244, v116, v117 bitop3:0x96
    v_bitop3_b32 v244, v244, v118, v119 bitop3:0x96
    v_xor_b32 v244, s33, v244
    s_waitcnt vmcnt(0)
    v_bitop3_b32 v245, v245, v120, v121 bitop3:0x96
    v_bitop3_b32 v245, v245, v122, v123 bitop3:0x96
    v_bitop3_b32 v245, v245, v124, v125 bitop3:0x96
    v_bitop3_b32 v245, v245, v126, v127 bitop3:0x96
    v_xor_b32 v245, s33, v245
L_b_wochk:
    v_or_b32 v2, v232, v233
    v_or3_b32 v2, v2, v234, v235
    v_or3_b32 v2, v2, v236, v237
    v_or3_b32 v2, v2, v238, v239
    v_or3_b32 v2, v2, v240, v241
    v_or3_b32 v2, v2, v242, v243
    v_or3_b32 v2, v2, v244, v245
    v_cmp_ne_u32 vcc, 0, v2
    s_nop 0
    s_cbranch_vccnz L_b_wopoll
L_b_wod:
    s_waitcnt vmcnt(0)
    v_add_u32 v5, 32768, v14
    s_mul_i32 s56, s30, 5120
    s_add_u32 s56, s56, 131072
    v_and_b32 v6, 31, v1
    v_mul_u32_u24 v6, 80, v6
    v_lshrrev_b32 v7, 5, v1
    v_lshl_add_u32 v6, v7, 3, v6
    v_add_u32 v6, s56, v6
    v_lshrrev_b32 v7, 2, v1
    v_mul_u32_u24 v8, 80, v7
    v_and_b32 v9, 3, v1
    v_lshl_add_u32 v8, v9, 4, v8
    v_add_u32 v8, s56, v8
    v_mul_u32_u24 v7, 1792, v7
    v_lshl_add_u32 v7, v9, 4, v7
    s_mul_i32 s56, s93, 57344
    s_lshl_b32 s55, s92, 2
    s_add_u32 s55, s55, s30
    s_lshl_b32 s54, s55, 6
    s_add_u32 s56, s56, s54
    s_add_u32 s56, s56, 896
    s_cmp_eq_u32 s89, 0
    s_cselect_b32 s56, s56, 0x7f000000
    v_mov_b32 v2, 159744
    s_mov_b32 s91, 0
L_of0:
    ds_read_b128 v[168:171], v2 offset:0
    s_add_u32 s91, s91, 1
    s_cmp_gt_u32 s91, 0x100000
    s_cbranch_scc1 L_of0_d
    s_waitcnt lgkmcnt(0)
    v_xor_b32 v168, s33, v168
    v_xor_b32 v169, s33, v169
    v_xor_b32 v170, s33, v170
    v_xor_b32 v171, s33, v171
    v_or3_b32 v168, v168, v169, v170
    v_or_b32 v168, v168, v171
    v_cmp_ne_u32 vcc, 0, v168
    s_nop 0
    s_cbranch_vccz L_of0_d
    s_sleep 1
    s_branch L_of0
L_of0_d:
    s_waitcnt lgkmcnt(0)
    ds_read_b128 v[128:131], v5 offset:0
    ds_read_b128 v[132:135], v5 offset:1024
    ds_read_b128 v[136:139], v5 offset:2048
    ds_read_b128 v[140:143], v5 offset:3072
    ds_read_b128 v[144:147], v5 offset:4096
    ds_read_b128 v[148:151], v5 offset:5120
    ds_read_b128 v[152:155], v5 offset:6144
    ds_read_b128 v[156:159], v5 offset:7168
    s_waitcnt lgkmcnt(7)
    v_mfma_f32_32x32x16_bf16 v[192:207], v[16:19], v[128:131], 0
    ds_read_b128 v[128:131], v5 offset:8192
    s_waitcnt lgkmcnt(7)
    v_mfma_f32_32x32x16_bf16 v[192:207], v[20:23], v[132:135], v[192:207]
    ds_read_b128 v[132:135], v5 offset:9216
    s_waitcnt lgkmcnt(7)
    v_mfma_f32_32x32x16_bf16 v[192:207], v[24:27], v[136:139], v[192:207]
    ds_read_b128 v[136:139], v5 offset:10240
    s_waitcnt lgkmcnt(7)
    v_mfma_f32_32x32x16_bf16 v[192:207], v[28:31], v[140:143], v[192:207]
    ds_read_b128 v[140:143], v5 offset:11264
    s_waitcnt lgkmcnt(7)
    v_mfma_f32_32x32x16_bf16 v[192:207], v[32:35], v[144:147], v[192:207]
    ds_read_b128 v[144:147], v5 offset:12288
    s_waitcnt lgkmcnt(7)
    v_mfma_f32_32x32x16_bf16 v[192:207], v[36:39], v[148:151], v[192:207]
    ds_read_b128 v[148:151], v5 offset:13312
    s_waitcnt lgkmcnt(7)
    v_mfma_f32_32x32x16_bf16 v[192:207], v[40:43], v[152:155], v[192:207]
    ds_read_b128 v[152:155], v5 offset:14336
    s_waitcnt lgkmcnt(7)
    v_mfma_f32_32x32x16_bf16 v[192:207], v[44:47], v[156:159], v[192:207]
    ds_read_b128 v[156:159], v5 offset:15360
    s_waitcnt lgkmcnt(7)
    v_mfma_f32_32x32x16_bf16 v[192:207], v[48:51], v[128:131], v[192:207]
    ds_read_b128 v[128:131], v5 offset:16384
    s_waitcnt lgkmcnt(7)
    v_mfma_f32_32x32x16_bf16 v[192:207], v[52:55], v[132:135], v[192:207]
    ds_read_b128 v[132:135], v5 offset:17408
    s_waitcnt lgkmcnt(7)
    v_mfma_f32_32x32x16_bf16 v[192:207], v[56:59], v[136:139], v[192:207]
    ds_read_b128 v[136:139], v5 offset:18432
    s_waitcnt lgkmcnt(7)
    v_mfma_f32_32x32x16_bf16 v[192:207], v[60:63], v[140:143], v[192:207]
    ds_read_b128 v[140:143], v5 offset:19456
    s_waitcnt lgkmcnt(7)
    v_mfma_f32_32x32x16_bf16 v[192:207], v[64:67], v[144:147], v[192:207]
    ds_read_b128 v[144:147], v5 offset:20480
    s_waitcnt lgkmcnt(7)
    v_mfma_f32_32x32x16_bf16 v[192:207], v[68:71], v[148:151], v[192:207]
    ds_read_b128 v[148:151], v5 offset:21504
    s_waitcnt lgkmcnt(7)
    v_mfma_f32_32x32x16_bf16 v[192:207], v[72:75], v[152:155], v[192:207]
    ds_read_b128 v[152:155], v5 offset:22528
    s_waitcnt lgkmcnt(7)
    v_mfma_f32_32x32x16_bf16 v[192:207], v[76:79], v[156:159], v[192:207]
    ds_read_b128 v[156:159], v5 offset:23552
    s_waitcnt lgkmcnt(7)
    v_mfma_f32_32x32x16_bf16 v[192:207], v[80:83], v[128:131], v[192:207]
    ds_read_b128 v[128:131], v5 offset:24576
    s_waitcnt lgkmcnt(7)
    v_mfma_f32_32x32x16_bf16 v[192:207], v[84:87], v[132:135], v[192:207]
    ds_read_b128 v[132:135], v5 offset:25600
    s_waitcnt lgkmcnt(7)
    v_mfma_f32_32x32x16_bf16 v[192:207], v[88:91], v[136:139], v[192:207]
    ds_read_b128 v[136:139], v5 offset:26624
    s_waitcnt lgkmcnt(7)
    v_mfma_f32_32x32x16_bf16 v[192:207], v[92:95], v[140:143], v[192:207]
    ds_read_b128 v[140:143], v5 offset:27648
    s_waitcnt lgkmcnt(7)
    v_mfma_f32_32x32x16_bf16 v[192:207], v[96:99], v[144:147], v[192:207]
    s_waitcnt lgkmcnt(6)
    v_mfma_f32_32x32x16_bf16 v[192:207], v[100:103], v[148:151], v[192:207]
    s_waitcnt lgkmcnt(5)
    v_mfma_f32_32x32x16_bf16 v[192:207], v[104:107], v[152:155], v[192:207]
    s_waitcnt lgkmcnt(4)
    v_mfma_f32_32x32x16_bf16 v[192:207], v[108:111], v[156:159], v[192:207]
    s_waitcnt lgkmcnt(3)
    v_mfma_f32_32x32x16_bf16 v[192:207], v[112:115], v[128:131], v[192:207]
    s_waitcnt lgkmcnt(2)
    v_mfma_f32_32x32x16_bf16 v[192:207], v[116:119], v[132:135], v[192:207]
    s_waitcnt lgkmcnt(1)
    v_mfma_f32_32x32x16_bf16 v[192:207], v[120:123], v[136:139], v[192:207]
    s_waitcnt lgkmcnt(0)
    v_mfma_f32_32x32x16_bf16 v[192:207], v[124:127], v[140:143], v[192:207]
    s_mov_b32 s91, 0
L_of1:
    ds_read_b128 v[168:171], v2 offset:16
    s_add_u32 s91, s91, 1
    s_cmp_gt_u32 s91, 0x100000
    s_cbranch_scc1 L_of1_d
    s_waitcnt lgkmcnt(0)
    v_xor_b32 v168, s33, v168
    v_xor_b32 v169, s33, v169
    v_xor_b32 v170, s33, v170
    v_xor_b32 v171, s33, v171
    v_or3_b32 v168, v168, v169, v170
    v_or_b32 v168, v168, v171
    v_cmp_ne_u32 vcc, 0, v168
    s_nop 0
    s_cbranch_vccz L_of1_d
    s_sleep 1
    s_branch L_of1
L_of1_d:
    s_waitcnt lgkmcnt(0)
    ds_read_b128 v[128:131], v5 offset:28672
    ds_read_b128 v[132:135], v5 offset:29696
    ds_read_b128 v[136:139], v5 offset:30720
    ds_read_b128 v[140:143], v5 offset:31744
    ds_read_b128 v[144:147], v5 offset:32768
    ds_read_b128 v[148:151], v5 offset:33792
    ds_read_b128 v[152:155], v5 offset:34816
    ds_read_b128 v[156:159], v5 offset:35840
    s_waitcnt lgkmcnt(7)
    v_mfma_f32_32x32x16_bf16 v[208:223], v[16:19], v[128:131], 0
    ds_read_b128 v[128:131], v5 offset:36864
    s_waitcnt lgkmcnt(7)
    v_mfma_f32_32x32x16_bf16 v[208:223], v[20:23], v[132:135], v[208:223]
    ds_read_b128 v[132:135], v5 offset:37888
    s_waitcnt lgkmcnt(7)
    v_mfma_f32_32x32x16_bf16 v[208:223], v[24:27], v[136:139], v[208:223]
    ds_read_b128 v[136:139], v5 offset:38912
    s_waitcnt lgkmcnt(7)
    v_mfma_f32_32x32x16_bf16 v[208:223], v[28:31], v[140:143], v[208:223]
    v_cvt_pk_bf16_f32 v224, v192, v193
    v_cvt_pk_bf16_f32 v225, v194, v195
    v_cvt_pk_bf16_f32 v226, v196, v197
    v_cvt_pk_bf16_f32 v227, v198, v199
    v_cvt_pk_bf16_f32 v228, v200, v201
    v_cvt_pk_bf16_f32 v229, v202, v203
    v_cvt_pk_bf16_f32 v230, v204, v205
    v_cvt_pk_bf16_f32 v231, v206, v207
    ds_write2_b64 v6, v[224:225], v[226:227] offset0:0 offset1:2
    ds_write2_b64 v6, v[228:229], v[230:231] offset0:4 offset1:6
    ds_read_b128 v[160:163], v8 offset:0
    ds_read_b128 v[164:167], v8 offset:1280
    ds_read_b128 v[140:143], v5 offset:39936
    s_waitcnt lgkmcnt(7)
    v_mfma_f32_32x32x16_bf16 v[208:223], v[32:35], v[144:147], v[208:223]
    ds_read_b128 v[144:147], v5 offset:40960
    s_waitcnt lgkmcnt(7)
    v_mfma_f32_32x32x16_bf16 v[208:223], v[36:39], v[148:151], v[208:223]
    ds_read_b128 v[148:151], v5 offset:41984
    s_waitcnt lgkmcnt(7)
    v_mfma_f32_32x32x16_bf16 v[208:223], v[40:43], v[152:155], v[208:223]
    ds_read_b128 v[152:155], v5 offset:43008
    s_waitcnt lgkmcnt(7)
    v_mfma_f32_32x32x16_bf16 v[208:223], v[44:47], v[156:159], v[208:223]
    ds_read_b128 v[156:159], v5 offset:44032
    s_waitcnt lgkmcnt(7)
    v_mfma_f32_32x32x16_bf16 v[208:223], v[48:51], v[128:131], v[208:223]
    ds_read_b128 v[128:131], v5 offset:45056
    s_waitcnt lgkmcnt(7)
    v_mfma_f32_32x32x16_bf16 v[208:223], v[52:55], v[132:135], v[208:223]
    ds_read_b128 v[132:135], v5 offset:46080
    s_waitcnt lgkmcnt(7)
    v_mfma_f32_32x32x16_bf16 v[208:223], v[56:59], v[136:139], v[208:223]
    ds_read_b128 v[136:139], v5 offset:47104
    s_waitcnt lgkmcnt(7)
    v_mfma_f32_32x32x16_bf16 v[208:223], v[60:63], v[140:143], v[208:223]
    ds_read_b128 v[140:143], v5 offset:48128
    s_waitcnt lgkmcnt(7)
    v_mfma_f32_32x32x16_bf16 v[208:223], v[64:67], v[144:147], v[208:223]
    ds_read_b128 v[144:147], v5 offset:49152
    s_waitcnt lgkmcnt(7)
    v_mfma_f32_32x32x16_bf16 v[208:223], v[68:71], v[148:151], v[208:223]
    ds_read_b128 v[148:151], v5 offset:50176
    s_waitcnt lgkmcnt(7)
    v_mfma_f32_32x32x16_bf16 v[208:223], v[72:75], v[152:155], v[208:223]
    buffer_store_dwordx4 v[160:163], v7, s[8:11], s56 offen sc1
    s_add_u32 s56, s56, 28672
    buffer_store_dwordx4 v[164:167], v7, s[8:11], s56 offen sc1
    s_add_u32 s56, s56, 28672
    ds_read_b128 v[152:155], v5 offset:51200
    s_waitcnt lgkmcnt(7)
    v_mfma_f32_32x32x16_bf16 v[208:223], v[76:79], v[156:159], v[208:223]
    ds_read_b128 v[156:159], v5 offset:52224
    s_waitcnt lgkmcnt(7)
    v_mfma_f32_32x32x16_bf16 v[208:223], v[80:83], v[128:131], v[208:223]
    ds_read_b128 v[128:131], v5 offset:53248
    s_waitcnt lgkmcnt(7)
    v_mfma_f32_32x32x16_bf16 v[208:223], v[84:87], v[132:135], v[208:223]
    ds_read_b128 v[132:135], v5 offset:54272
    s_waitcnt lgkmcnt(7)
    v_mfma_f32_32x32x16_bf16 v[208:223], v[88:91], v[136:139], v[208:223]
    ds_read_b128 v[136:139], v5 offset:55296
    s_waitcnt lgkmcnt(7)
    v_mfma_f32_32x32x16_bf16 v[208:223], v[92:95], v[140:143], v[208:223]
    ds_read_b128 v[140:143], v5 offset:56320
    s_waitcnt lgkmcnt(7)
    v_mfma_f32_32x32x16_bf16 v[208:223], v[96:99], v[144:147], v[208:223]
    s_waitcnt lgkmcnt(6)
    v_mfma_f32_32x32x16_bf16 v[208:223], v[100:103], v[148:151], v[208:223]
    s_waitcnt lgkmcnt(5)
    v_mfma_f32_32x32x16_bf16 v[208:223], v[104:107], v[152:155], v[208:223]
    s_waitcnt lgkmcnt(4)
    v_mfma_f32_32x32x16_bf16 v[208:223], v[108:111], v[156:159], v[208:223]
    s_waitcnt lgkmcnt(3)
    v_mfma_f32_32x32x16_bf16 v[208:223], v[112:115], v[128:131], v[208:223]
    s_waitcnt lgkmcnt(2)
    v_mfma_f32_32x32x16_bf16 v[208:223], v[116:119], v[132:135], v[208:223]
    s_waitcnt lgkmcnt(1)
    v_mfma_f32_32x32x16_bf16 v[208:223], v[120:123], v[136:139], v[208:223]
    s_waitcnt lgkmcnt(0)
    v_mfma_f32_32x32x16_bf16 v[208:223], v[124:127], v[140:143], v[208:223]
    s_nop 11
    v_cvt_pk_bf16_f32 v224, v208, v209
    v_cvt_pk_bf16_f32 v225, v210, v211
    v_cvt_pk_bf16_f32 v226, v212, v213
    v_cvt_pk_bf16_f32 v227, v214, v215
    v_cvt_pk_bf16_f32 v228, v216, v217
    v_cvt_pk_bf16_f32 v229, v218, v219
    v_cvt_pk_bf16_f32 v230, v220, v221
    v_cvt_pk_bf16_f32 v231, v222, v223
    ds_write2_b64 v6, v[224:225], v[226:227] offset0:0 offset1:2
    ds_write2_b64 v6, v[228:229], v[230:231] offset0:4 offset1:6
    ds_read_b128 v[160:163], v8 offset:0
    ds_read_b128 v[164:167], v8 offset:1280
    s_waitcnt lgkmcnt(0)
    buffer_store_dwordx4 v[160:163], v7, s[8:11], s56 offen sc1
    s_add_u32 s56, s56, 28672
    buffer_store_dwordx4 v[164:167], v7, s[8:11], s56 offen sc1
    s_add_u32 s56, s56, 28672
L_b_fin:
    s_endpgm
L_teamA:
    s_mov_b32 s96, s24
    s_and_b32 s97, s25, 0xffff
    s_mov_b32 s98, 3670016
    s_mov_b32 s99, 0x00020000
    s_mov_b64 s[12:13], s[20:21]
    s_mov_b32 s20, s28
    s_and_b32 s21, s29, 0xffff
    s_mov_b32 s22, 268435456
    s_mov_b32 s23, 0x00020000
    v_lshlrev_b32 v2, 4, v1
    v_and_b32 v4, 3, v1
    v_lshrrev_b32 v5, 4, v1
    v_bfe_u32 v6, v1, 2, 2
    v_and_b32 v3, 7, v1
    v_lshrrev_b32 v12, 3, v1
    v_and_b32 v13, 15, v1
    v_and_b32 v14, 1, v1
    s_lshl_b32 s42, s31, 7
    v_mul_u32_u24 v230, 1792, v12
    v_lshl_add_u32 v230, v3, 4, v230
    s_mul_i32 s41, s59, 28672
    s_add_u32 s41, s41, s42
    v_add_u32 v230, s41, v230
    v_add_u32 v226, s39, v2
    v_bfe_u32 v15, v1, 1, 3
    v_mul_u32_u24 v247, 544, v13
    v_lshl_add_u32 v247, v5, 4, v247
    v_lshlrev_b32 v248, 3, v1
    v_add_u32 v248, s39, v248
    v_add_u32 v247, s39, v247
    v_lshlrev_b32 v243, 7, v6
    v_lshl_add_u32 v243, v5, 5, v243
    v_lshl_add_u32 v243, v4, 3, v243
    v_add_u32 v243, s101, v243
    v_lshrrev_b32 v18, 2, v1
    v_mul_u32_u24 v241, 20480, v18
    s_lshl_b32 s41, s31, 9
    s_add_u32 s41, s41, s32
    s_mul_i32 s41, s41, 640
    s_add_u32 s41, s41, 3145728
    s_lshl_b32 s42, s36, 5
    s_add_u32 s42, s42, s41
    v_lshl_add_u32 v242, v4, 3, v241
    v_add_u32 v242, s42, v242
    s_lshl_b32 s42, s36, 7
    s_add_u32 s42, s42, s41
    v_lshl_add_u32 v241, v4, 4, v241
    v_add_u32 v241, s42, v241
    s_lshl_b32 s41, s31, 4
    s_lshr_b32 s42, s32, 1
    s_add_u32 s41, s41, s42
    s_lshl_b32 s41, s41, 2
    s_add_u32 s41, s41, s36
    s_mul_i32 s41, s41, 5120
    s_add_u32 s88, s41, 3145728
    v_mul_u32_u24 v231, 640, v12
    v_add_u32 v231, s88, v231
    s_and_b32 s42, s32, 1
    s_lshl_b32 s42, s42, 1
    v_add_u32 v19, s42, v14
    v_bfe_u32 v20, v1, 1, 2
    v_lshl_add_u32 v21, v20, 2, v19
    v_lshl_add_u32 v232, v21, 3, v231
    v_lshl_add_u32 v21, v20, 3, v19
    v_lshl_add_u32 v231, v21, 4, v231
    v_mul_u32_u24 v233, 9152, v14
    v_lshrrev_b32 v21, 1, v1
    v_lshl_add_u32 v233, v21, 5, v233
    s_lshl_b32 s41, s36, 10
    s_add_u32 s42, s41, 35264
    s_add_u32 s42, s42, s87
    v_add_u32 v233, s42, v233
    s_add_u32 s41, s41, s100
    v_lshlrev_b32 v237, 6, v15
    v_lshl_add_u32 v237, v14, 3, v237
    v_lshl_add_u32 v237, v5, 4, v237
    v_add_u32 v237, s41, v237
    v_add_u32 v238, s41, v2
    v_mul_u32_u24 v234, 56, v13
    v_lshl_add_u32 v234, v5, 3, v234
    s_lshl_b32 s41, s37, 11
    s_mul_i32 s42, s38, 896
    s_add_u32 s41, s41, s42
    s_add_u32 s41, s41, s100
    v_add_u32 v234, s41, v234
    s_xor_b32 s41, s36, 1
    s_mul_i32 s41, s41, 8704
    s_add_u32 s41, s41, s87
    v_add_u32 v245, s41, v2
    s_mul_i32 s41, s37, 17408
    s_add_u32 s41, s41, s87
    s_lshl_b32 s42, s38, 11
    s_add_u32 s42, s42, s41
    v_add_u32 v244, s42, v2
    v_mul_u32_u24 v246, 4160, v18
    v_lshl_add_u32 v246, v4, 4, v246
    v_add_u32 v246, s41, v246
    v_mul_u32_u24 v235, 4160, v4
    v_sub_u32 v21, v5, v6
    v_lshl_add_u32 v235, v21, 4, v235
    s_add_u32 s41, s41, 496
    v_add_u32 v235, s41, v235
    v_xor_b32 v21, 1, v14
    v_mul_u32_u24 v236, 4576, v21
    v_lshl_add_u32 v236, v5, 4, v236
    v_lshl_add_u32 v236, v15, 6, v236
    s_mul_i32 s41, s37, 9152
    s_add_u32 s41, s41, 35264
    s_add_u32 s41, s41, s87
    v_add_u32 v236, s41, v236
    v_bfe_u32 v21, v1, 1, 4
    v_mul_u32_u24 v239, 160, v21
    s_lshl_b32 s41, s31, 4
    s_lshr_b32 s42, s32, 1
    s_add_u32 s42, s42, s41
    s_mul_i32 s42, s42, 20480
    s_add_u32 s42, s42, 3145728
    v_add_u32 v239, s42, v239
    s_and_b32 s42, s32, 1
    s_lshl_b32 s42, s42, 1
    s_add_u32 s42, s42, s37
    s_lshl_b32 s42, s42, 1
    v_add_u32 v21, s42, v14
    v_lshl_add_u32 v240, v21, 2, v239
    v_lshl_add_u32 v239, v21, 4, v239
    s_mul_i32 s41, s41, 20480
    s_mul_i32 s42, s59, 160
    s_add_u32 s41, s41, s42
    s_add_u32 s41, s41, 3145728
    v_mul_u32_u24 v224, 20480, v12
    v_add_u32 v224, s41, v224
    v_lshl_add_u32 v225, v3, 2, v224
    v_lshl_add_u32 v224, v3, 4, v224
    v_lshl_add_u32 v227, v5, 3, v6
    v_lshlrev_b32 v227, 5, v227
    v_lshl_add_u32 v227, v4, 3, v227
    v_add_u32 v227, s39, v227
    s_add_u32 s41, s39, 2048
    v_mul_u32_u24 v228, 144, v13
    v_lshl_add_u32 v228, v5, 4, v228
    v_add_u32 v228, s41, v228
    v_mul_u32_u24 v229, 144, v12
    v_lshl_add_u32 v229, v3, 4, v229
    v_add_u32 v229, s41, v229
    s_mul_i32 s41, s36, 4576
    s_add_u32 s41, s41, 34816
    s_add_u32 s41, s41, s87
    v_add_u32 v21, s41, v2
    v_mov_b32 v24, 0
    v_mov_b32 v25, 0
    v_mov_b32 v26, 0
    v_mov_b32 v27, 0
    s_mov_b32 exec_lo, 0x0fffffff
    s_mov_b32 exec_hi, 0
    ds_write_b128 v21, v[24:27]
    s_lshl_b32 s41, s38, 28
    s_or_b32 exec_lo, s41, 1
    ds_write_b64 v21, v[24:25]
    s_mov_b64 exec, -1
    v_mov_b32 v7, 0
    s_cmp_lt_u32 s30, 4
    s_cbranch_scc1 L_a_w0
    s_waitcnt vmcnt(5)
L_a_w0:
    s_waitcnt lgkmcnt(0)
    s_mov_b32 s44, s56
    s_cmp_lt_u32 s30, 4
    s_cbranch_scc0 L_a_nl2
    s_waitcnt vmcnt(0)
    v_mov_b32 v21, 0
    v_mov_b32 v22, 1
    s_mov_b64 exec, 1
    ds_add_u32 v21, v22 offset:28
    s_mov_b64 exec, -1
L_a_nl2:
    s_waitcnt lgkmcnt(0)
    s_lshl_b32 s41, s37, 4
    s_lshr_b32 s50, s50, s41
    s_lshl_b32 s50, s50, 16
    s_lshr_b32 s51, s51, s41
    s_lshl_b32 s51, s51, 16
    s_mov_b32 s42, 0x3fb8aa3b
    s_mov_b32 s43, 0xffff0000
    v_mov_b32 v46, s50
    v_mul_f32 v46, s42, v46
    v_lshlrev_b32 v48, 16, v8
    v_and_b32 v49, s43, v8
    v_exp_f32 v46, v46
    v_mul_f32 v48, s42, v48
    v_mul_f32 v49, s42, v49
    v_exp_f32 v48, v48
    v_exp_f32 v49, v49
    v_cvt_pk_bf16_f32 v46, v46, v46
    v_and_b32 v46, s43, v46
    v_cvt_pk_bf16_f32 v48, v48, v49
    v_lshlrev_b32 v28, 16, v9
    v_and_b32 v29, s43, v9
    v_lshlrev_b32 v26, 16, v48
    v_and_b32 v27, s43, v48
    v_pk_mul_f32 v[28:29], v[28:29], v[46:47] op_sel_hi:[1,0]
    v_pk_mul_f32 v[26:27], v[26:27], v[46:47] op_sel_hi:[1,0]
    v_mul_f32 v28, 0x3e22f983, v28
    v_mul_f32 v26, 0xbfb8aa3b, v26
    v_mul_f32 v29, 0x3e22f983, v29
    v_mul_f32 v27, 0xbfb8aa3b, v27
    v_add_f32 v46, v46, v46
    v_lshlrev_b32 v30, 16, v10
    v_and_b32 v32, s43, v10
    v_lshlrev_b32 v31, 16, v11
    v_and_b32 v33, s43, v11
    v_pk_mul_f32 v[30:31], v[30:31], v[46:47] op_sel_hi:[1,0] neg_hi:[1,0]
    v_pk_mul_f32 v[32:33], v[32:33], v[46:47] op_sel_hi:[1,0] neg_hi:[1,0]
    v_exp_f32 v46, v26
    v_fract_f32 v47, v28
    v_exp_f32 v50, v27
    v_fract_f32 v51, v29
    v_cos_f32 v48, v47
    v_sin_f32 v49, v47
    v_cos_f32 v52, v51
    v_sin_f32 v53, v51
    v_pk_mul_f32 v[34:35], v[48:49], v[46:47] op_sel_hi:[1,0] neg_hi:[1,0]
    v_pk_mul_f32 v[36:37], v[52:53], v[50:51] op_sel_hi:[1,0] neg_hi:[1,0]
    v_mul_f32 v46, 0x43800000, v26
    v_mul_f32 v47, 0x43800000, v28
    v_exp_f32 v46, v46
    v_fract_f32 v47, v47
    v_mul_f32 v50, 0x43800000, v27
    v_mul_f32 v51, 0x43800000, v29
    v_exp_f32 v50, v50
    v_fract_f32 v51, v51
    v_cos_f32 v48, v47
    v_sin_f32 v49, v47
    v_cos_f32 v52, v51
    v_sin_f32 v53, v51
    v_pk_mul_f32 v[42:43], v[48:49], v[46:47] op_sel_hi:[1,0] neg_hi:[1,0]
    v_pk_mul_f32 v[44:45], v[52:53], v[50:51] op_sel_hi:[1,0] neg_hi:[1,0]
    v_mul_f32 v46, 0x41000000, v26
    v_mul_f32 v47, 0x41000000, v28
    v_exp_f32 v46, v46
    v_fract_f32 v47, v47
    v_mul_f32 v50, 0x41000000, v27
    v_mul_f32 v51, 0x41000000, v29
    v_exp_f32 v50, v50
    v_fract_f32 v51, v51
    v_cos_f32 v48, v47
    v_sin_f32 v49, v47
    v_cos_f32 v52, v51
    v_sin_f32 v53, v51
    v_pk_mul_f32 v[38:39], v[48:49], v[46:47] op_sel_hi:[1,0]
    v_pk_mul_f32 v[40:41], v[52:53], v[50:51] op_sel_hi:[1,0]
    v_pk_mul_f32 v[16:17], v[30:31], v[34:35] op_sel:[0,0] op_sel_hi:[0,1]
    v_pk_mul_f32 v[18:19], v[32:33], v[36:37] op_sel:[0,0] op_sel_hi:[0,1]
    v_cvt_pk_bf16_f32 v8, v30, v31
    v_cvt_pk_bf16_f32 v9, v32, v33
    v_pk_fma_f32 v[68:69], v[30:31], v[34:35], v[16:17] op_sel:[1,1,0] op_sel_hi:[1,0,1] neg_lo:[0,1,0]
    v_pk_fma_f32 v[70:71], v[32:33], v[36:37], v[18:19] op_sel:[1,1,0] op_sel_hi:[1,0,1] neg_lo:[0,1,0]
    ds_write_b64 v248, v[8:9] offset:0
    v_pk_mul_f32 v[16:17], v[68:69], v[34:35] op_sel:[0,0] op_sel_hi:[0,1]
    v_pk_mul_f32 v[18:19], v[70:71], v[36:37] op_sel:[0,0] op_sel_hi:[0,1]
    v_cvt_pk_bf16_f32 v10, v68, v69
    v_cvt_pk_bf16_f32 v11, v70, v71
    v_pk_fma_f32 v[72:73], v[68:69], v[34:35], v[16:17] op_sel:[1,1,0] op_sel_hi:[1,0,1] neg_lo:[0,1,0]
    v_pk_fma_f32 v[74:75], v[70:71], v[36:37], v[18:19] op_sel:[1,1,0] op_sel_hi:[1,0,1] neg_lo:[0,1,0]
    ds_write_b64 v248, v[10:11] offset:544
    v_pk_mul_f32 v[16:17], v[72:73], v[34:35] op_sel:[0,0] op_sel_hi:[0,1]
    v_pk_mul_f32 v[18:19], v[74:75], v[36:37] op_sel:[0,0] op_sel_hi:[0,1]
    v_cvt_pk_bf16_f32 v12, v72, v73
    v_cvt_pk_bf16_f32 v13, v74, v75
    v_pk_fma_f32 v[76:77], v[72:73], v[34:35], v[16:17] op_sel:[1,1,0] op_sel_hi:[1,0,1] neg_lo:[0,1,0]
    v_pk_fma_f32 v[78:79], v[74:75], v[36:37], v[18:19] op_sel:[1,1,0] op_sel_hi:[1,0,1] neg_lo:[0,1,0]
    ds_write_b64 v248, v[12:13] offset:1088
    v_pk_mul_f32 v[16:17], v[76:77], v[34:35] op_sel:[0,0] op_sel_hi:[0,1]
    v_pk_mul_f32 v[18:19], v[78:79], v[36:37] op_sel:[0,0] op_sel_hi:[0,1]
    v_cvt_pk_bf16_f32 v14, v76, v77
    v_cvt_pk_bf16_f32 v15, v78, v79
    v_pk_fma_f32 v[80:81], v[76:77], v[34:35], v[16:17] op_sel:[1,1,0] op_sel_hi:[1,0,1] neg_lo:[0,1,0]
    v_pk_fma_f32 v[82:83], v[78:79], v[36:37], v[18:19] op_sel:[1,1,0] op_sel_hi:[1,0,1] neg_lo:[0,1,0]
    ds_write_b64 v248, v[14:15] offset:1632
    v_pk_mul_f32 v[16:17], v[80:81], v[34:35] op_sel:[0,0] op_sel_hi:[0,1]
    v_pk_mul_f32 v[18:19], v[82:83], v[36:37] op_sel:[0,0] op_sel_hi:[0,1]
    v_cvt_pk_bf16_f32 v8, v80, v81
    v_cvt_pk_bf16_f32 v9, v82, v83
    v_pk_fma_f32 v[84:85], v[80:81], v[34:35], v[16:17] op_sel:[1,1,0] op_sel_hi:[1,0,1] neg_lo:[0,1,0]
    v_pk_fma_f32 v[86:87], v[82:83], v[36:37], v[18:19] op_sel:[1,1,0] op_sel_hi:[1,0,1] neg_lo:[0,1,0]
    ds_write_b64 v248, v[8:9] offset:2176
    v_pk_mul_f32 v[16:17], v[84:85], v[34:35] op_sel:[0,0] op_sel_hi:[0,1]
    v_pk_mul_f32 v[18:19], v[86:87], v[36:37] op_sel:[0,0] op_sel_hi:[0,1]
    v_cvt_pk_bf16_f32 v10, v84, v85
    v_cvt_pk_bf16_f32 v11, v86, v87
    v_pk_fma_f32 v[88:89], v[84:85], v[34:35], v[16:17] op_sel:[1,1,0] op_sel_hi:[1,0,1] neg_lo:[0,1,0]
    v_pk_fma_f32 v[90:91], v[86:87], v[36:37], v[18:19] op_sel:[1,1,0] op_sel_hi:[1,0,1] neg_lo:[0,1,0]
    ds_write_b64 v248, v[10:11] offset:2720
    v_pk_mul_f32 v[16:17], v[88:89], v[34:35] op_sel:[0,0] op_sel_hi:[0,1]
    v_pk_mul_f32 v[18:19], v[90:91], v[36:37] op_sel:[0,0] op_sel_hi:[0,1]
    v_cvt_pk_bf16_f32 v12, v88, v89
    v_cvt_pk_bf16_f32 v13, v90, v91
    v_pk_fma_f32 v[92:93], v[88:89], v[34:35], v[16:17] op_sel:[1,1,0] op_sel_hi:[1,0,1] neg_lo:[0,1,0]
    v_pk_fma_f32 v[94:95], v[90:91], v[36:37], v[18:19] op_sel:[1,1,0] op_sel_hi:[1,0,1] neg_lo:[0,1,0]
    ds_write_b64 v248, v[12:13] offset:3264
    v_pk_mul_f32 v[16:17], v[30:31], v[42:43] op_sel:[0,0] op_sel_hi:[0,1]
    v_pk_mul_f32 v[18:19], v[32:33], v[44:45] op_sel:[0,0] op_sel_hi:[0,1]
    v_cvt_pk_bf16_f32 v14, v92, v93
    v_cvt_pk_bf16_f32 v15, v94, v95
    v_pk_fma_f32 v[68:69], v[30:31], v[42:43], v[16:17] op_sel:[1,1,0] op_sel_hi:[1,0,1] neg_lo:[0,1,0]
    v_pk_fma_f32 v[70:71], v[32:33], v[44:45], v[18:19] op_sel:[1,1,0] op_sel_hi:[1,0,1] neg_lo:[0,1,0]
    ds_write_b64 v248, v[14:15] offset:3808
    v_pk_mul_f32 v[16:17], v[72:73], v[42:43] op_sel:[0,0] op_sel_hi:[0,1]
    v_pk_mul_f32 v[18:19], v[74:75], v[44:45] op_sel:[0,0] op_sel_hi:[0,1]
    v_cvt_pk_bf16_f32 v8, v68, v69
    v_cvt_pk_bf16_f32 v9, v70, v71
    v_pk_fma_f32 v[76:77], v[72:73], v[42:43], v[16:17] op_sel:[1,1,0] op_sel_hi:[1,0,1] neg_lo:[0,1,0]
    v_pk_fma_f32 v[78:79], v[74:75], v[44:45], v[18:19] op_sel:[1,1,0] op_sel_hi:[1,0,1] neg_lo:[0,1,0]
    ds_write_b64 v248, v[8:9] offset:4352
    v_pk_mul_f32 v[16:17], v[80:81], v[42:43] op_sel:[0,0] op_sel_hi:[0,1]
    v_pk_mul_f32 v[18:19], v[82:83], v[44:45] op_sel:[0,0] op_sel_hi:[0,1]
    v_cvt_pk_bf16_f32 v10, v76, v77
    v_cvt_pk_bf16_f32 v11, v78, v79
    v_pk_fma_f32 v[84:85], v[80:81], v[42:43], v[16:17] op_sel:[1,1,0] op_sel_hi:[1,0,1] neg_lo:[0,1,0]
    v_pk_fma_f32 v[86:87], v[82:83], v[44:45], v[18:19] op_sel:[1,1,0] op_sel_hi:[1,0,1] neg_lo:[0,1,0]
    ds_write_b64 v248, v[10:11] offset:4896
    v_pk_mul_f32 v[16:17], v[88:89], v[42:43] op_sel:[0,0] op_sel_hi:[0,1]
    v_pk_mul_f32 v[18:19], v[90:91], v[44:45] op_sel:[0,0] op_sel_hi:[0,1]
    v_cvt_pk_bf16_f32 v12, v84, v85
    v_cvt_pk_bf16_f32 v13, v86, v87
    v_pk_fma_f32 v[64:65], v[88:89], v[42:43], v[16:17] op_sel:[1,1,0] op_sel_hi:[1,0,1] neg_lo:[0,1,0]
    v_pk_fma_f32 v[66:67], v[90:91], v[44:45], v[18:19] op_sel:[1,1,0] op_sel_hi:[1,0,1] neg_lo:[0,1,0]
    ds_write_b64 v248, v[12:13] offset:5440
    v_pk_mul_f32 v[16:17], v[68:69], v[42:43] op_sel:[0,0] op_sel_hi:[0,1]
    v_pk_mul_f32 v[18:19], v[70:71], v[44:45] op_sel:[0,0] op_sel_hi:[0,1]
    v_cvt_pk_bf16_f32 v14, v64, v65
    v_cvt_pk_bf16_f32 v15, v66, v67
    v_pk_fma_f32 v[96:97], v[68:69], v[42:43], v[16:17] op_sel:[1,1,0] op_sel_hi:[1,0,1] neg_lo:[0,1,0]
    v_pk_fma_f32 v[98:99], v[70:71], v[44:45], v[18:19] op_sel:[1,1,0] op_sel_hi:[1,0,1] neg_lo:[0,1,0]
    ds_write_b64 v248, v[14:15] offset:5984
    v_pk_mul_f32 v[16:17], v[84:85], v[42:43] op_sel:[0,0] op_sel_hi:[0,1]
    v_pk_mul_f32 v[18:19], v[86:87], v[44:45] op_sel:[0,0] op_sel_hi:[0,1]
    v_cvt_pk_bf16_f32 v8, v96, v97
    v_cvt_pk_bf16_f32 v9, v98, v99
    v_pk_fma_f32 v[100:101], v[84:85], v[42:43], v[16:17] op_sel:[1,1,0] op_sel_hi:[1,0,1] neg_lo:[0,1,0]
    v_pk_fma_f32 v[102:103], v[86:87], v[44:45], v[18:19] op_sel:[1,1,0] op_sel_hi:[1,0,1] neg_lo:[0,1,0]
    ds_write_b64 v248, v[8:9] offset:6528
    v_pk_mul_f32 v[16:17], v[96:97], v[42:43] op_sel:[0,0] op_sel_hi:[0,1]
    v_pk_mul_f32 v[18:19], v[98:99], v[44:45] op_sel:[0,0] op_sel_hi:[0,1]
    v_cvt_pk_bf16_f32 v10, v100, v101
    v_cvt_pk_bf16_f32 v11, v102, v103
    v_pk_fma_f32 v[104:105], v[96:97], v[42:43], v[16:17] op_sel:[1,1,0] op_sel_hi:[1,0,1] neg_lo:[0,1,0]
    v_pk_fma_f32 v[106:107], v[98:99], v[44:45], v[18:19] op_sel:[1,1,0] op_sel_hi:[1,0,1] neg_lo:[0,1,0]
    ds_write_b64 v248, v[10:11] offset:7072
    v_pk_mul_f32 v[16:17], v[100:101], v[42:43] op_sel:[0,0] op_sel_hi:[0,1]
    v_pk_mul_f32 v[18:19], v[102:103], v[44:45] op_sel:[0,0] op_sel_hi:[0,1]
    v_cvt_pk_bf16_f32 v12, v104, v105
    v_cvt_pk_bf16_f32 v13, v106, v107
    v_pk_fma_f32 v[92:93], v[100:101], v[42:43], v[16:17] op_sel:[1,1,0] op_sel_hi:[1,0,1] neg_lo:[0,1,0]
    v_pk_fma_f32 v[94:95], v[102:103], v[44:45], v[18:19] op_sel:[1,1,0] op_sel_hi:[1,0,1] neg_lo:[0,1,0]
    ds_write_b64 v248, v[12:13] offset:7616
    v_cvt_pk_bf16_f32 v14, v92, v93
    v_cvt_pk_bf16_f32 v15, v94, v95
    ds_write_b64 v248, v[14:15] offset:8160
    ds_read_b128 v[128:131], v247 offset:0
    ds_read_b128 v[132:135], v247 offset:64
    ds_read_b128 v[136:139], v247 offset:128
    ds_read_b128 v[140:143], v247 offset:192
    ds_read_b128 v[144:147], v247 offset:256
    ds_read_b128 v[148:151], v247 offset:320
    ds_read_b128 v[152:155], v247 offset:384
    ds_read_b128 v[156:159], v247 offset:448
    s_cmp_lt_u32 s30, 4
    s_cbranch_scc0 L_a_nu
    s_add_u32 m0, s101, 0
    s_add_u32 s41, s44, 0
    buffer_load_dwordx4 v62, s[52:55], s41 offen lds
    s_add_u32 m0, s101, 1024
    s_add_u32 s41, s44, 7168
    buffer_load_dwordx4 v62, s[52:55], s41 offen lds
    s_add_u32 m0, s101, 2048
    s_add_u32 s41, s44, 57344
    buffer_load_dwordx4 v62, s[52:55], s41 offen lds
    s_add_u32 m0, s101, 3072
    s_add_u32 s41, s44, 64512
    buffer_load_dwordx4 v62, s[52:55], s41 offen lds
    v_lshlrev_b32 v22, 7, v1
    s_mov_b32 exec_hi, 0xff
    buffer_load_dword v250, v22, s[20:23], s88 offen sc1
    s_mov_b32 exec_hi, -1
L_a_nu:
    v_pk_mul_f32 v[16:17], v[104:105], v[42:43] op_sel:[0,0] op_sel_hi:[0,1]
    v_pk_mul_f32 v[18:19], v[106:107], v[44:45] op_sel:[0,0] op_sel_hi:[0,1]
    v_pk_fma_f32 v[72:73], v[104:105], v[42:43], v[16:17] op_sel:[1,1,0] op_sel_hi:[1,0,1] neg_lo:[0,1,0]
    v_pk_fma_f32 v[74:75], v[106:107], v[44:45], v[18:19] op_sel:[1,1,0] op_sel_hi:[1,0,1] neg_lo:[0,1,0]
    v_pk_mul_f32 v[16:17], v[72:73], v[42:43] op_sel:[0,0] op_sel_hi:[0,1]
    v_pk_mul_f32 v[18:19], v[74:75], v[44:45] op_sel:[0,0] op_sel_hi:[0,1]
    v_cvt_pk_bf16_f32 v8, v72, v73
    v_cvt_pk_bf16_f32 v9, v74, v75
    v_pk_fma_f32 v[80:81], v[72:73], v[42:43], v[16:17] op_sel:[1,1,0] op_sel_hi:[1,0,1] neg_lo:[0,1,0]
    v_pk_fma_f32 v[82:83], v[74:75], v[44:45], v[18:19] op_sel:[1,1,0] op_sel_hi:[1,0,1] neg_lo:[0,1,0]
    ds_write_b64 v248, v[8:9] offset:0
    v_pk_mul_f32 v[16:17], v[80:81], v[42:43] op_sel:[0,0] op_sel_hi:[0,1]
    v_pk_mul_f32 v[18:19], v[82:83], v[44:45] op_sel:[0,0] op_sel_hi:[0,1]
    v_cvt_pk_bf16_f32 v10, v80, v81
    v_cvt_pk_bf16_f32 v11, v82, v83
    v_pk_fma_f32 v[72:73], v[80:81], v[42:43], v[16:17] op_sel:[1,1,0] op_sel_hi:[1,0,1] neg_lo:[0,1,0]
    v_pk_fma_f32 v[74:75], v[82:83], v[44:45], v[18:19] op_sel:[1,1,0] op_sel_hi:[1,0,1] neg_lo:[0,1,0]
    ds_write_b64 v248, v[10:11] offset:544
    v_pk_mul_f32 v[16:17], v[72:73], v[42:43] op_sel:[0,0] op_sel_hi:[0,1]
    v_pk_mul_f32 v[18:19], v[74:75], v[44:45] op_sel:[0,0] op_sel_hi:[0,1]
    v_cvt_pk_bf16_f32 v12, v72, v73
    v_cvt_pk_bf16_f32 v13, v74, v75
    v_pk_fma_f32 v[80:81], v[72:73], v[42:43], v[16:17] op_sel:[1,1,0] op_sel_hi:[1,0,1] neg_lo:[0,1,0]
    v_pk_fma_f32 v[82:83], v[74:75], v[44:45], v[18:19] op_sel:[1,1,0] op_sel_hi:[1,0,1] neg_lo:[0,1,0]
    ds_write_b64 v248, v[12:13] offset:1088
    v_pk_mul_f32 v[16:17], v[80:81], v[42:43] op_sel:[0,0] op_sel_hi:[0,1]
    v_pk_mul_f32 v[18:19], v[82:83], v[44:45] op_sel:[0,0] op_sel_hi:[0,1]
    v_cvt_pk_bf16_f32 v14, v80, v81
    v_cvt_pk_bf16_f32 v15, v82, v83
    v_pk_fma_f32 v[72:73], v[80:81], v[42:43], v[16:17] op_sel:[1,1,0] op_sel_hi:[1,0,1] neg_lo:[0,1,0]
    v_pk_fma_f32 v[74:75], v[82:83], v[44:45], v[18:19] op_sel:[1,1,0] op_sel_hi:[1,0,1] neg_lo:[0,1,0]
    ds_write_b64 v248, v[14:15] offset:1632
    v_cvt_pk_bf16_f32 v8, v72, v73
    v_cvt_pk_bf16_f32 v9, v74, v75
    ds_write_b64 v248, v[8:9] offset:2176
    ds_read_b128 v[160:163], v247 offset:0
    ds_read_b128 v[164:167], v247 offset:64
    ds_read_b128 v[168:171], v247 offset:128
    ds_read_b128 v[172:175], v247 offset:192
    ds_read_b128 v[176:179], v247 offset:256
    ds_read_b128 v[180:183], v247 offset:320
    ds_read_b128 v[184:187], v247 offset:384
    ds_read_b128 v[188:191], v247 offset:448
    s_mul_i32 s41, s38, 3072
    s_add_u32 s41, s41, 131328
    v_add_u32 v20, s41, v2
    v_mov_b32 v21, 0
    s_mov_b32 s91, 0
Ls_4:
    ds_read_b32 v22, v21 offset:28
    ds_read_b128 v[54:57], v20 offset:0
    ds_read_b128 v[58:61], v20 offset:1024
    ds_read_b128 v[108:111], v20 offset:2048
    s_add_u32 s91, s91, 1
    s_cmp_gt_u32 s91, 0x40000
    s_cbranch_scc1 Lsd_5
    s_waitcnt lgkmcnt(3)
    v_readfirstlane_b32 s90, v22
    s_nop 0
    s_cmp_lt_u32 s90, 4
    s_cbranch_scc1 Ls_4
Lsd_5:
    s_load_dword s33, s[26:27], 0
    v_mov_b32 v8, 0x3f80
    v_mov_b32 v9, 0x3f80
    ds_write_b64 v248, v[8:9] offset:0
    v_pk_mul_f32 v[16:17], v[38:39], v[38:39] op_sel:[0,0] op_sel_hi:[0,1]
    v_pk_mul_f32 v[18:19], v[40:41], v[40:41] op_sel:[0,0] op_sel_hi:[0,1]
    v_cvt_pk_bf16_f32 v10, v38, v39
    v_cvt_pk_bf16_f32 v11, v40, v41
    v_pk_fma_f32 v[64:65], v[38:39], v[38:39], v[16:17] op_sel:[1,1,0] op_sel_hi:[1,0,1] neg_lo:[0,1,0]
    v_pk_fma_f32 v[66:67], v[40:41], v[40:41], v[18:19] op_sel:[1,1,0] op_sel_hi:[1,0,1] neg_lo:[0,1,0]
    ds_write_b64 v248, v[10:11] offset:544
    v_pk_mul_f32 v[16:17], v[64:65], v[38:39] op_sel:[0,0] op_sel_hi:[0,1]
    v_pk_mul_f32 v[18:19], v[66:67], v[40:41] op_sel:[0,0] op_sel_hi:[0,1]
    v_cvt_pk_bf16_f32 v12, v64, v65
    v_cvt_pk_bf16_f32 v13, v66, v67
    v_pk_fma_f32 v[68:69], v[64:65], v[38:39], v[16:17] op_sel:[1,1,0] op_sel_hi:[1,0,1] neg_lo:[0,1,0]
    v_pk_fma_f32 v[70:71], v[66:67], v[40:41], v[18:19] op_sel:[1,1,0] op_sel_hi:[1,0,1] neg_lo:[0,1,0]
    ds_write_b64 v248, v[12:13] offset:1088
    v_pk_mul_f32 v[16:17], v[68:69], v[38:39] op_sel:[0,0] op_sel_hi:[0,1]
    v_pk_mul_f32 v[18:19], v[70:71], v[40:41] op_sel:[0,0] op_sel_hi:[0,1]
    v_cvt_pk_bf16_f32 v14, v68, v69
    v_cvt_pk_bf16_f32 v15, v70, v71
    v_pk_fma_f32 v[64:65], v[68:69], v[38:39], v[16:17] op_sel:[1,1,0] op_sel_hi:[1,0,1] neg_lo:[0,1,0]
    v_pk_fma_f32 v[66:67], v[70:71], v[40:41], v[18:19] op_sel:[1,1,0] op_sel_hi:[1,0,1] neg_lo:[0,1,0]
    ds_write_b64 v248, v[14:15] offset:1632
    v_pk_mul_f32 v[16:17], v[64:65], v[38:39] op_sel:[0,0] op_sel_hi:[0,1]
    v_pk_mul_f32 v[18:19], v[66:67], v[40:41] op_sel:[0,0] op_sel_hi:[0,1]
    v_cvt_pk_bf16_f32 v8, v64, v65
    v_cvt_pk_bf16_f32 v9, v66, v67
    v_pk_fma_f32 v[68:69], v[64:65], v[38:39], v[16:17] op_sel:[1,1,0] op_sel_hi:[1,0,1] neg_lo:[0,1,0]
    v_pk_fma_f32 v[70:71], v[66:67], v[40:41], v[18:19] op_sel:[1,1,0] op_sel_hi:[1,0,1] neg_lo:[0,1,0]
    ds_write_b64 v248, v[8:9] offset:2176
    v_pk_mul_f32 v[16:17], v[68:69], v[38:39] op_sel:[0,0] op_sel_hi:[0,1]
    v_pk_mul_f32 v[18:19], v[70:71], v[40:41] op_sel:[0,0] op_sel_hi:[0,1]
    v_cvt_pk_bf16_f32 v10, v68, v69
    v_cvt_pk_bf16_f32 v11, v70, v71
    v_pk_fma_f32 v[64:65], v[68:69], v[38:39], v[16:17] op_sel:[1,1,0] op_sel_hi:[1,0,1] neg_lo:[0,1,0]
    v_pk_fma_f32 v[66:67], v[70:71], v[40:41], v[18:19] op_sel:[1,1,0] op_sel_hi:[1,0,1] neg_lo:[0,1,0]
    ds_write_b64 v248, v[10:11] offset:2720
    v_pk_mul_f32 v[16:17], v[64:65], v[38:39] op_sel:[0,0] op_sel_hi:[0,1]
    v_pk_mul_f32 v[18:19], v[66:67], v[40:41] op_sel:[0,0] op_sel_hi:[0,1]
    v_cvt_pk_bf16_f32 v12, v64, v65
    v_cvt_pk_bf16_f32 v13, v66, v67
    v_pk_fma_f32 v[68:69], v[64:65], v[38:39], v[16:17] op_sel:[1,1,0] op_sel_hi:[1,0,1] neg_lo:[0,1,0]
    v_pk_fma_f32 v[70:71], v[66:67], v[40:41], v[18:19] op_sel:[1,1,0] op_sel_hi:[1,0,1] neg_lo:[0,1,0]
    ds_write_b64 v248, v[12:13] offset:3264
    v_pk_mul_f32 v[16:17], v[68:69], v[38:39] op_sel:[0,0] op_sel_hi:[0,1]
    v_pk_mul_f32 v[18:19], v[70:71], v[40:41] op_sel:[0,0] op_sel_hi:[0,1]
    v_cvt_pk_bf16_f32 v14, v68, v69
    v_cvt_pk_bf16_f32 v15, v70, v71
    v_pk_fma_f32 v[64:65], v[68:69], v[38:39], v[16:17] op_sel:[1,1,0] op_sel_hi:[1,0,1] neg_lo:[0,1,0]
    v_pk_fma_f32 v[66:67], v[70:71], v[40:41], v[18:19] op_sel:[1,1,0] op_sel_hi:[1,0,1] neg_lo:[0,1,0]
    ds_write_b64 v248, v[14:15] offset:3808
    v_pk_mul_f32 v[16:17], v[64:65], v[38:39] op_sel:[0,0] op_sel_hi:[0,1]
    v_pk_mul_f32 v[18:19], v[66:67], v[40:41] op_sel:[0,0] op_sel_hi:[0,1]
    v_cvt_pk_bf16_f32 v8, v64, v65
    v_cvt_pk_bf16_f32 v9, v66, v67
    v_pk_fma_f32 v[68:69], v[64:65], v[38:39], v[16:17] op_sel:[1,1,0] op_sel_hi:[1,0,1] neg_lo:[0,1,0]
    v_pk_fma_f32 v[70:71], v[66:67], v[40:41], v[18:19] op_sel:[1,1,0] op_sel_hi:[1,0,1] neg_lo:[0,1,0]
    ds_write_b64 v248, v[8:9] offset:4352
    v_pk_mul_f32 v[16:17], v[68:69], v[38:39] op_sel:[0,0] op_sel_hi:[0,1]
    v_pk_mul_f32 v[18:19], v[70:71], v[40:41] op_sel:[0,0] op_sel_hi:[0,1]
    v_cvt_pk_bf16_f32 v10, v68, v69
    v_cvt_pk_bf16_f32 v11, v70, v71
    v_pk_fma_f32 v[64:65], v[68:69], v[38:39], v[16:17] op_sel:[1,1,0] op_sel_hi:[1,0,1] neg_lo:[0,1,0]
    v_pk_fma_f32 v[66:67], v[70:71], v[40:41], v[18:19] op_sel:[1,1,0] op_sel_hi:[1,0,1] neg_lo:[0,1,0]
    ds_write_b64 v248, v[10:11] offset:4896
    v_pk_mul_f32 v[16:17], v[64:65], v[38:39] op_sel:[0,0] op_sel_hi:[0,1]
    v_pk_mul_f32 v[18:19], v[66:67], v[40:41] op_sel:[0,0] op_sel_hi:[0,1]
    v_cvt_pk_bf16_f32 v12, v64, v65
    v_cvt_pk_bf16_f32 v13, v66, v67
    v_pk_fma_f32 v[68:69], v[64:65], v[38:39], v[16:17] op_sel:[1,1,0] op_sel_hi:[1,0,1] neg_lo:[0,1,0]
    v_pk_fma_f32 v[70:71], v[66:67], v[40:41], v[18:19] op_sel:[1,1,0] op_sel_hi:[1,0,1] neg_lo:[0,1,0]
    ds_write_b64 v248, v[12:13] offset:5440
    v_pk_mul_f32 v[16:17], v[68:69], v[38:39] op_sel:[0,0] op_sel_hi:[0,1]
    v_pk_mul_f32 v[18:19], v[70:71], v[40:41] op_sel:[0,0] op_sel_hi:[0,1]
    v_cvt_pk_bf16_f32 v14, v68, v69
    v_cvt_pk_bf16_f32 v15, v70, v71
    v_pk_fma_f32 v[64:65], v[68:69], v[38:39], v[16:17] op_sel:[1,1,0] op_sel_hi:[1,0,1] neg_lo:[0,1,0]
    v_pk_fma_f32 v[66:67], v[70:71], v[40:41], v[18:19] op_sel:[1,1,0] op_sel_hi:[1,0,1] neg_lo:[0,1,0]
    ds_write_b64 v248, v[14:15] offset:5984
    v_pk_mul_f32 v[16:17], v[64:65], v[38:39] op_sel:[0,0] op_sel_hi:[0,1]
    v_pk_mul_f32 v[18:19], v[66:67], v[40:41] op_sel:[0,0] op_sel_hi:[0,1]
    v_cvt_pk_bf16_f32 v8, v64, v65
    v_cvt_pk_bf16_f32 v9, v66, v67
    v_pk_fma_f32 v[68:69], v[64:65], v[38:39], v[16:17] op_sel:[1,1,0] op_sel_hi:[1,0,1] neg_lo:[0,1,0]
    v_pk_fma_f32 v[70:71], v[66:67], v[40:41], v[18:19] op_sel:[1,1,0] op_sel_hi:[1,0,1] neg_lo:[0,1,0]
    ds_write_b64 v248, v[8:9] offset:6528
    v_pk_mul_f32 v[16:17], v[68:69], v[38:39] op_sel:[0,0] op_sel_hi:[0,1]
    v_pk_mul_f32 v[18:19], v[70:71], v[40:41] op_sel:[0,0] op_sel_hi:[0,1]
    v_cvt_pk_bf16_f32 v10, v68, v69
    v_cvt_pk_bf16_f32 v11, v70, v71
    v_pk_fma_f32 v[64:65], v[68:69], v[38:39], v[16:17] op_sel:[1,1,0] op_sel_hi:[1,0,1] neg_lo:[0,1,0]
    v_pk_fma_f32 v[66:67], v[70:71], v[40:41], v[18:19] op_sel:[1,1,0] op_sel_hi:[1,0,1] neg_lo:[0,1,0]
    ds_write_b64 v248, v[10:11] offset:7072
    v_pk_mul_f32 v[16:17], v[64:65], v[38:39] op_sel:[0,0] op_sel_hi:[0,1]
    v_pk_mul_f32 v[18:19], v[66:67], v[40:41] op_sel:[0,0] op_sel_hi:[0,1]
    v_cvt_pk_bf16_f32 v12, v64, v65
    v_cvt_pk_bf16_f32 v13, v66, v67
    v_pk_fma_f32 v[68:69], v[64:65], v[38:39], v[16:17] op_sel:[1,1,0] op_sel_hi:[1,0,1] neg_lo:[0,1,0]
    v_pk_fma_f32 v[70:71], v[66:67], v[40:41], v[18:19] op_sel:[1,1,0] op_sel_hi:[1,0,1] neg_lo:[0,1,0]
    ds_write_b64 v248, v[12:13] offset:7616
    v_cvt_pk_bf16_f32 v14, v68, v69
    v_cvt_pk_bf16_f32 v15, v70, v71
    ds_write_b64 v248, v[14:15] offset:8160
    ds_read_b128 v[192:195], v247 offset:0
    ds_read_b128 v[196:199], v247 offset:64
    ds_read_b128 v[200:203], v247 offset:128
    ds_read_b128 v[204:207], v247 offset:192
    ds_read_b128 v[208:211], v247 offset:256
    ds_read_b128 v[212:215], v247 offset:320
    ds_read_b128 v[216:219], v247 offset:384
    ds_read_b128 v[220:223], v247 offset:448
    s_waitcnt lgkmcnt(0)
    s_lshl_b32 s41, s86, 5
    s_lshl_b32 s42, s37, 11
    s_add_u32 s41, s41, s42
    s_mul_i32 s41, s41, 0x10001
    v_add_u32 v54, s41, v54
    v_add_u32 v55, s41, v55
    v_add_u32 v56, s41, v56
    v_add_u32 v57, s41, v57
    v_add_u32 v58, s41, v58
    v_add_u32 v59, s41, v59
    v_add_u32 v60, s41, v60
    v_add_u32 v61, s41, v61
    v_add_u32 v108, s41, v108
    v_add_u32 v109, s41, v109
    v_add_u32 v110, s41, v110
    v_add_u32 v111, s41, v111
    s_cmp_lg_u32 s33, 0
    s_cbranch_scc1 L_a_gn
    s_mov_b32 s91, 0
Ln_6:
    global_load_dword v249, v7, s[26:27] sc1
    s_waitcnt vmcnt(0)
Lnc_7:
    v_readfirstlane_b32 s33, v249
    s_add_u32 s91, s91, 1
    s_cmp_gt_u32 s91, 0x4000
    s_cbranch_scc1 Lnd_8
    s_cmp_eq_u32 s33, 0
    s_cbranch_scc1 Ln_6
Lnd_8:
    s_or_b32 s33, s33, 1
L_a_gn:
    s_cmp_eq_u32 s30, 0
    s_cbranch_scc0 L_a_nl
    s_getreg_b32 s41, hwreg(HW_REG_XCC_ID)
    s_and_b32 s41, s41, 15
    s_lshl_b32 s41, s41, 4
    s_xor_b32 s41, s41, s33
    v_mov_b32 v22, s41
    s_lshl_b32 s41, s31, 5
    s_add_u32 s41, s41, s3
    s_lshl_b32 s41, s41, 3
    s_add_u32 s41, s41, 6029312
    v_mov_b32 v21, s41
    v_mov_b32 v23, v22
    s_mov_b64 exec, 1
    buffer_store_dwordx2 v[22:23], v21, s[20:23], 0 offen
    s_mov_b64 exec, -1
L_a_nl:
    s_cmp_lt_u32 s30, 4
    s_cbranch_scc0 L_a_np0
    v_lshlrev_b32 v22, 7, v1
    s_waitcnt vmcnt(0)
    ds_read_b64_tr_b16 v[72:73], v243 offset:0
    ds_read_b64_tr_b16 v[74:75], v243 offset:512
    ds_read_b64_tr_b16 v[76:77], v243 offset:1024
    ds_read_b64_tr_b16 v[78:79], v243 offset:1536
    ds_read_b64_tr_b16 v[82:83], v243 offset:2048
    ds_read_b64_tr_b16 v[84:85], v243 offset:2560
    ds_read_b64_tr_b16 v[86:87], v243 offset:3072
    ds_read_b64_tr_b16 v[88:89], v243 offset:3584
    s_waitcnt lgkmcnt(4)
    buffer_store_dwordx4 v[72:75], v241, s[20:23], 0 offen offset:0
    buffer_store_dwordx4 v[76:79], v241, s[20:23], 0 offen offset:64
    v_bitop3_b32 v80, v72, v73, s33 bitop3:0x96
    v_bitop3_b32 v80, v80, v74, v75 bitop3:0x96
    v_bitop3_b32 v80, v80, v76, v77 bitop3:0x96
    v_bitop3_b32 v80, v80, v78, v79 bitop3:0x96
    v_mov_b32 v81, v80
    buffer_store_dwordx2 v[80:81], v242, s[20:23], 0 offen offset:512
    s_waitcnt lgkmcnt(0)
    buffer_store_dwordx4 v[82:85], v241, s[20:23], 0 offen offset:640
    buffer_store_dwordx4 v[86:89], v241, s[20:23], 0 offen offset:704
    v_bitop3_b32 v90, v82, v83, s33 bitop3:0x96
    v_bitop3_b32 v90, v90, v84, v85 bitop3:0x96
    v_bitop3_b32 v90, v90, v86, v87 bitop3:0x96
    v_bitop3_b32 v90, v90, v88, v89 bitop3:0x96
    v_mov_b32 v91, v90
    buffer_store_dwordx2 v[90:91], v242, s[20:23], 0 offen offset:1152
L_a_np0:
    s_setprio 2
    v_pk_mul_f32 v[16:17], v[68:69], v[38:39] op_sel:[0,0] op_sel_hi:[0,1]
    v_pk_mul_f32 v[18:19], v[70:71], v[40:41] op_sel:[0,0] op_sel_hi:[0,1]
    v_pk_fma_f32 v[64:65], v[68:69], v[38:39], v[16:17] op_sel:[1,1,0] op_sel_hi:[1,0,1] neg_lo:[0,1,0]
    v_pk_fma_f32 v[66:67], v[70:71], v[40:41], v[18:19] op_sel:[1,1,0] op_sel_hi:[1,0,1] neg_lo:[0,1,0]
    v_mfma_f32_16x16x32_bf16 v[112:115], v[128:131], v[192:195], 0
    v_pk_mul_f32 v[16:17], v[64:65], v[38:39] op_sel:[0,0] op_sel_hi:[0,1]
    v_pk_mul_f32 v[18:19], v[66:67], v[40:41] op_sel:[0,0] op_sel_hi:[0,1]
    v_cvt_pk_bf16_f32 v8, v64, v65
    v_cvt_pk_bf16_f32 v9, v66, v67
    v_pk_fma_f32 v[68:69], v[64:65], v[38:39], v[16:17] op_sel:[1,1,0] op_sel_hi:[1,0,1] neg_lo:[0,1,0]
    v_pk_fma_f32 v[70:71], v[66:67], v[40:41], v[18:19] op_sel:[1,1,0] op_sel_hi:[1,0,1] neg_lo:[0,1,0]
    ds_write_b64 v248, v[8:9] offset:0
    v_mfma_f32_16x16x32_bf16 v[120:123], v[160:163], v[192:195], 0
    v_pk_mul_f32 v[16:17], v[68:69], v[38:39] op_sel:[0,0] op_sel_hi:[0,1]
    v_pk_mul_f32 v[18:19], v[70:71], v[40:41] op_sel:[0,0] op_sel_hi:[0,1]
    v_cvt_pk_bf16_f32 v10, v68, v69
    v_cvt_pk_bf16_f32 v11, v70, v71
    v_pk_fma_f32 v[64:65], v[68:69], v[38:39], v[16:17] op_sel:[1,1,0] op_sel_hi:[1,0,1] neg_lo:[0,1,0]
    v_pk_fma_f32 v[66:67], v[70:71], v[40:41], v[18:19] op_sel:[1,1,0] op_sel_hi:[1,0,1] neg_lo:[0,1,0]
    ds_write_b64 v248, v[10:11] offset:544
    v_mfma_f32_16x16x32_bf16 v[112:115], v[132:135], v[196:199], v[112:115]
    v_pk_mul_f32 v[16:17], v[64:65], v[38:39] op_sel:[0,0] op_sel_hi:[0,1]
    v_pk_mul_f32 v[18:19], v[66:67], v[40:41] op_sel:[0,0] op_sel_hi:[0,1]
    v_cvt_pk_bf16_f32 v12, v64, v65
    v_cvt_pk_bf16_f32 v13, v66, v67
    v_pk_fma_f32 v[68:69], v[64:65], v[38:39], v[16:17] op_sel:[1,1,0] op_sel_hi:[1,0,1] neg_lo:[0,1,0]
    v_pk_fma_f32 v[70:71], v[66:67], v[40:41], v[18:19] op_sel:[1,1,0] op_sel_hi:[1,0,1] neg_lo:[0,1,0]
    ds_write_b64 v248, v[12:13] offset:1088
    v_mfma_f32_16x16x32_bf16 v[120:123], v[164:167], v[196:199], v[120:123]
    v_pk_mul_f32 v[16:17], v[68:69], v[38:39] op_sel:[0,0] op_sel_hi:[0,1]
    v_pk_mul_f32 v[18:19], v[70:71], v[40:41] op_sel:[0,0] op_sel_hi:[0,1]
    v_cvt_pk_bf16_f32 v14, v68, v69
    v_cvt_pk_bf16_f32 v15, v70, v71
    v_pk_fma_f32 v[64:65], v[68:69], v[38:39], v[16:17] op_sel:[1,1,0] op_sel_hi:[1,0,1] neg_lo:[0,1,0]
    v_pk_fma_f32 v[66:67], v[70:71], v[40:41], v[18:19] op_sel:[1,1,0] op_sel_hi:[1,0,1] neg_lo:[0,1,0]
    ds_write_b64 v248, v[14:15] offset:1632
    v_mfma_f32_16x16x32_bf16 v[112:115], v[136:139], v[200:203], v[112:115]
    v_pk_mul_f32 v[16:17], v[64:65], v[38:39] op_sel:[0,0] op_sel_hi:[0,1]
    v_pk_mul_f32 v[18:19], v[66:67], v[40:41] op_sel:[0,0] op_sel_hi:[0,1]
    v_cvt_pk_bf16_f32 v8, v64, v65
    v_cvt_pk_bf16_f32 v9, v66, v67
    v_pk_fma_f32 v[68:69], v[64:65], v[38:39], v[16:17] op_sel:[1,1,0] op_sel_hi:[1,0,1] neg_lo:[0,1,0]
    v_pk_fma_f32 v[70:71], v[66:67], v[40:41], v[18:19] op_sel:[1,1,0] op_sel_hi:[1,0,1] neg_lo:[0,1,0]
    ds_write_b64 v248, v[8:9] offset:2176
    v_mfma_f32_16x16x32_bf16 v[120:123], v[168:171], v[200:203], v[120:123]
    v_pk_mul_f32 v[16:17], v[68:69], v[38:39] op_sel:[0,0] op_sel_hi:[0,1]
    v_pk_mul_f32 v[18:19], v[70:71], v[40:41] op_sel:[0,0] op_sel_hi:[0,1]
    v_cvt_pk_bf16_f32 v10, v68, v69
    v_cvt_pk_bf16_f32 v11, v70, v71
    v_pk_fma_f32 v[64:65], v[68:69], v[38:39], v[16:17] op_sel:[1,1,0] op_sel_hi:[1,0,1] neg_lo:[0,1,0]
    v_pk_fma_f32 v[66:67], v[70:71], v[40:41], v[18:19] op_sel:[1,1,0] op_sel_hi:[1,0,1] neg_lo:[0,1,0]
    ds_write_b64 v248, v[10:11] offset:2720
    v_mfma_f32_16x16x32_bf16 v[112:115], v[140:143], v[204:207], v[112:115]
    v_pk_mul_f32 v[16:17], v[64:65], v[38:39] op_sel:[0,0] op_sel_hi:[0,1]
    v_pk_mul_f32 v[18:19], v[66:67], v[40:41] op_sel:[0,0] op_sel_hi:[0,1]
    v_cvt_pk_bf16_f32 v12, v64, v65
    v_cvt_pk_bf16_f32 v13, v66, v67
    v_pk_fma_f32 v[68:69], v[64:65], v[38:39], v[16:17] op_sel:[1,1,0] op_sel_hi:[1,0,1] neg_lo:[0,1,0]
    v_pk_fma_f32 v[70:71], v[66:67], v[40:41], v[18:19] op_sel:[1,1,0] op_sel_hi:[1,0,1] neg_lo:[0,1,0]
    ds_write_b64 v248, v[12:13] offset:3264
    v_mfma_f32_16x16x32_bf16 v[120:123], v[172:175], v[204:207], v[120:123]
    v_pk_mul_f32 v[16:17], v[68:69], v[38:39] op_sel:[0,0] op_sel_hi:[0,1]
    v_pk_mul_f32 v[18:19], v[70:71], v[40:41] op_sel:[0,0] op_sel_hi:[0,1]
    v_cvt_pk_bf16_f32 v14, v68, v69
    v_cvt_pk_bf16_f32 v15, v70, v71
    v_pk_fma_f32 v[64:65], v[68:69], v[38:39], v[16:17] op_sel:[1,1,0] op_sel_hi:[1,0,1] neg_lo:[0,1,0]
    v_pk_fma_f32 v[66:67], v[70:71], v[40:41], v[18:19] op_sel:[1,1,0] op_sel_hi:[1,0,1] neg_lo:[0,1,0]
    ds_write_b64 v248, v[14:15] offset:3808
    v_mfma_f32_16x16x32_bf16 v[112:115], v[144:147], v[208:211], v[112:115]
    v_pk_mul_f32 v[16:17], v[64:65], v[38:39] op_sel:[0,0] op_sel_hi:[0,1]
    v_pk_mul_f32 v[18:19], v[66:67], v[40:41] op_sel:[0,0] op_sel_hi:[0,1]
    v_cvt_pk_bf16_f32 v8, v64, v65
    v_cvt_pk_bf16_f32 v9, v66, v67
    v_pk_fma_f32 v[68:69], v[64:65], v[38:39], v[16:17] op_sel:[1,1,0] op_sel_hi:[1,0,1] neg_lo:[0,1,0]
    v_pk_fma_f32 v[70:71], v[66:67], v[40:41], v[18:19] op_sel:[1,1,0] op_sel_hi:[1,0,1] neg_lo:[0,1,0]
    ds_write_b64 v248, v[8:9] offset:4352
    v_mfma_f32_16x16x32_bf16 v[120:123], v[176:179], v[208:211], v[120:123]
    v_pk_mul_f32 v[16:17], v[68:69], v[38:39] op_sel:[0,0] op_sel_hi:[0,1]
    v_pk_mul_f32 v[18:19], v[70:71], v[40:41] op_sel:[0,0] op_sel_hi:[0,1]
    v_cvt_pk_bf16_f32 v10, v68, v69
    v_cvt_pk_bf16_f32 v11, v70, v71
    v_pk_fma_f32 v[64:65], v[68:69], v[38:39], v[16:17] op_sel:[1,1,0] op_sel_hi:[1,0,1] neg_lo:[0,1,0]
    v_pk_fma_f32 v[66:67], v[70:71], v[40:41], v[18:19] op_sel:[1,1,0] op_sel_hi:[1,0,1] neg_lo:[0,1,0]
    ds_write_b64 v248, v[10:11] offset:4896
    v_mfma_f32_16x16x32_bf16 v[112:115], v[148:151], v[212:215], v[112:115]
    v_pk_mul_f32 v[16:17], v[64:65], v[38:39] op_sel:[0,0] op_sel_hi:[0,1]
    v_pk_mul_f32 v[18:19], v[66:67], v[40:41] op_sel:[0,0] op_sel_hi:[0,1]
    v_cvt_pk_bf16_f32 v12, v64, v65
    v_cvt_pk_bf16_f32 v13, v66, v67
    v_pk_fma_f32 v[68:69], v[64:65], v[38:39], v[16:17] op_sel:[1,1,0] op_sel_hi:[1,0,1] neg_lo:[0,1,0]
    v_pk_fma_f32 v[70:71], v[66:67], v[40:41], v[18:19] op_sel:[1,1,0] op_sel_hi:[1,0,1] neg_lo:[0,1,0]
    ds_write_b64 v248, v[12:13] offset:5440
    v_mfma_f32_16x16x32_bf16 v[120:123], v[180:183], v[212:215], v[120:123]
    v_pk_mul_f32 v[16:17], v[68:69], v[38:39] op_sel:[0,0] op_sel_hi:[0,1]
    v_pk_mul_f32 v[18:19], v[70:71], v[40:41] op_sel:[0,0] op_sel_hi:[0,1]
    v_cvt_pk_bf16_f32 v14, v68, v69
    v_cvt_pk_bf16_f32 v15, v70, v71
    v_pk_fma_f32 v[64:65], v[68:69], v[38:39], v[16:17] op_sel:[1,1,0] op_sel_hi:[1,0,1] neg_lo:[0,1,0]
    v_pk_fma_f32 v[66:67], v[70:71], v[40:41], v[18:19] op_sel:[1,1,0] op_sel_hi:[1,0,1] neg_lo:[0,1,0]
    ds_write_b64 v248, v[14:15] offset:5984
    v_mfma_f32_16x16x32_bf16 v[112:115], v[152:155], v[216:219], v[112:115]
    v_pk_mul_f32 v[16:17], v[64:65], v[38:39] op_sel:[0,0] op_sel_hi:[0,1]
    v_pk_mul_f32 v[18:19], v[66:67], v[40:41] op_sel:[0,0] op_sel_hi:[0,1]
    v_cvt_pk_bf16_f32 v8, v64, v65
    v_cvt_pk_bf16_f32 v9, v66, v67
    v_pk_fma_f32 v[68:69], v[64:65], v[38:39], v[16:17] op_sel:[1,1,0] op_sel_hi:[1,0,1] neg_lo:[0,1,0]
    v_pk_fma_f32 v[70:71], v[66:67], v[40:41], v[18:19] op_sel:[1,1,0] op_sel_hi:[1,0,1] neg_lo:[0,1,0]
    ds_write_b64 v248, v[8:9] offset:6528
    v_mfma_f32_16x16x32_bf16 v[120:123], v[184:187], v[216:219], v[120:123]
    v_pk_mul_f32 v[16:17], v[68:69], v[38:39] op_sel:[0,0] op_sel_hi:[0,1]
    v_pk_mul_f32 v[18:19], v[70:71], v[40:41] op_sel:[0,0] op_sel_hi:[0,1]
    v_cvt_pk_bf16_f32 v10, v68, v69
    v_cvt_pk_bf16_f32 v11, v70, v71
    v_pk_fma_f32 v[64:65], v[68:69], v[38:39], v[16:17] op_sel:[1,1,0] op_sel_hi:[1,0,1] neg_lo:[0,1,0]
    v_pk_fma_f32 v[66:67], v[70:71], v[40:41], v[18:19] op_sel:[1,1,0] op_sel_hi:[1,0,1] neg_lo:[0,1,0]
    ds_write_b64 v248, v[10:11] offset:7072
    v_mfma_f32_16x16x32_bf16 v[112:115], v[156:159], v[220:223], v[112:115]
    v_pk_mul_f32 v[16:17], v[64:65], v[38:39] op_sel:[0,0] op_sel_hi:[0,1]
    v_pk_mul_f32 v[18:19], v[66:67], v[40:41] op_sel:[0,0] op_sel_hi:[0,1]
    v_cvt_pk_bf16_f32 v12, v64, v65
    v_cvt_pk_bf16_f32 v13, v66, v67
    v_pk_fma_f32 v[68:69], v[64:65], v[38:39], v[16:17] op_sel:[1,1,0] op_sel_hi:[1,0,1] neg_lo:[0,1,0]
    v_pk_fma_f32 v[70:71], v[66:67], v[40:41], v[18:19] op_sel:[1,1,0] op_sel_hi:[1,0,1] neg_lo:[0,1,0]
    ds_write_b64 v248, v[12:13] offset:7616
    v_mfma_f32_16x16x32_bf16 v[120:123], v[188:191], v[220:223], v[120:123]
    v_cvt_pk_bf16_f32 v14, v68, v69
    v_cvt_pk_bf16_f32 v15, v70, v71
    ds_write_b64 v248, v[14:15] offset:8160
    ds_read_b128 v[192:195], v247 offset:0
    ds_read_b128 v[196:199], v247 offset:64
    ds_read_b128 v[200:203], v247 offset:128
    ds_read_b128 v[204:207], v247 offset:192
    ds_read_b128 v[208:211], v247 offset:256
    ds_read_b128 v[212:215], v247 offset:320
    ds_read_b128 v[216:219], v247 offset:384
    ds_read_b128 v[220:223], v247 offset:448
    s_cmp_eq_u32 s38, 0
    s_cselect_b64 s[56:57], -1, 0
    v_cmp_eq_u32 vcc, 0, v1
    s_nop 0
    s_and_b64 vcc, vcc, s[56:57]
    v_mov_b32 v16, s51
    v_cndmask_b32 v16, 0, v16, vcc
    v_cmp_eq_u32 s[48:49], 16, v1
    s_lshl_b32 s58, s37, 2
    s_add_u32 s58, s58, s86
    s_waitcnt lgkmcnt(7)
    v_mfma_f32_16x16x32_bf16 v[116:119], v[128:131], v[192:195], 0
    v_mfma_f32_16x16x32_bf16 v[124:127], v[160:163], v[192:195], 0
    s_waitcnt lgkmcnt(6)
    v_mfma_f32_16x16x32_bf16 v[116:119], v[132:135], v[196:199], v[116:119]
    v_mfma_f32_16x16x32_bf16 v[124:127], v[164:167], v[196:199], v[124:127]
    s_waitcnt lgkmcnt(5)
    v_mfma_f32_16x16x32_bf16 v[116:119], v[136:139], v[200:203], v[116:119]
    v_mfma_f32_16x16x32_bf16 v[124:127], v[168:171], v[200:203], v[124:127]
    s_waitcnt lgkmcnt(4)
    v_mfma_f32_16x16x32_bf16 v[116:119], v[140:143], v[204:207], v[116:119]
    v_mfma_f32_16x16x32_bf16 v[124:127], v[172:175], v[204:207], v[124:127]
    s_waitcnt lgkmcnt(3)
    v_mfma_f32_16x16x32_bf16 v[116:119], v[144:147], v[208:211], v[116:119]
    v_mfma_f32_16x16x32_bf16 v[124:127], v[176:179], v[208:211], v[124:127]
    s_waitcnt lgkmcnt(2)
    v_mfma_f32_16x16x32_bf16 v[116:119], v[148:151], v[212:215], v[116:119]
    v_mfma_f32_16x16x32_bf16 v[124:127], v[180:183], v[212:215], v[124:127]
    s_waitcnt lgkmcnt(1)
    v_mfma_f32_16x16x32_bf16 v[116:119], v[152:155], v[216:219], v[116:119]
    v_mfma_f32_16x16x32_bf16 v[124:127], v[184:187], v[216:219], v[124:127]
    s_waitcnt lgkmcnt(0)
    v_mfma_f32_16x16x32_bf16 v[116:119], v[156:159], v[220:223], v[116:119]
    v_mfma_f32_16x16x32_bf16 v[124:127], v[188:191], v[220:223], v[124:127]
    s_setprio 3
    s_nop 5
    v_cndmask_b32 v72, v112, v116, s[56:57]
    v_cndmask_b32 v73, v113, v117, s[56:57]
    v_cndmask_b32 v74, v114, v118, s[56:57]
    v_cndmask_b32 v75, v115, v119, s[56:57]
    v_cndmask_b32 v76, v120, v124, s[56:57]
    v_cndmask_b32 v77, v121, v125, s[56:57]
    v_cndmask_b32 v78, v122, v126, s[56:57]
    v_cndmask_b32 v79, v123, v127, s[56:57]
    ds_write_b128 v226, v[72:75]
    ds_write_b128 v226, v[76:79] offset:1024
    v_mov_b32 v10, s58
    v_mov_b32 v11, 1
    s_mov_b64 exec, 1
    ds_add_u32 v10, v11 offset:32
    s_mov_b64 exec, -1
    v_cndmask_b32 v64, v116, v112, s[56:57]
    v_cndmask_b32 v65, v117, v113, s[56:57]
    v_cndmask_b32 v66, v118, v114, s[56:57]
    v_cndmask_b32 v67, v119, v115, s[56:57]
    v_cndmask_b32 v68, v124, v120, s[56:57]
    v_cndmask_b32 v69, v125, v121, s[56:57]
    v_cndmask_b32 v70, v126, v122, s[56:57]
    v_cndmask_b32 v71, v127, v123, s[56:57]
    v_add_f32 v64, v64, v16
    v_and_b32 v128, 0xffff, v54
    v_lshrrev_b32 v129, 16, v54
    v_and_b32 v130, 0xffff, v55
    v_lshrrev_b32 v131, 16, v55
    v_and_b32 v132, 0xffff, v56
    v_lshrrev_b32 v133, 16, v56
    v_and_b32 v134, 0xffff, v57
    v_lshrrev_b32 v135, 16, v57
    v_and_b32 v136, 0xffff, v58
    v_lshrrev_b32 v137, 16, v58
    v_and_b32 v138, 0xffff, v59
    v_lshrrev_b32 v139, 16, v59
    v_and_b32 v140, 0xffff, v60
    v_lshrrev_b32 v141, 16, v60
    v_and_b32 v142, 0xffff, v61
    v_lshrrev_b32 v143, 16, v61
    v_and_b32 v144, 0xffff, v108
    v_lshrrev_b32 v145, 16, v108
    v_and_b32 v146, 0xffff, v109
    v_lshrrev_b32 v147, 16, v109
    v_and_b32 v148, 0xffff, v110
    v_lshrrev_b32 v149, 16, v110
    v_and_b32 v150, 0xffff, v111
    v_lshrrev_b32 v151, 16, v111
    v_mov_b32 v10, s58
    s_mov_b32 s91, 0
Ls_9:
    ds_read_b32 v11, v10 offset:32
    ds_read_b128 v[72:75], v245
    ds_read_b128 v[76:79], v245 offset:1024
    s_add_u32 s91, s91, 1
    s_cmp_gt_u32 s91, 0x40000
    s_cbranch_scc1 Lsd_10
    s_waitcnt lgkmcnt(2)
    v_readfirstlane_b32 s90, v11
    s_nop 0
    s_cmp_lt_u32 s90, 2
    s_cbranch_scc1 Ls_9
Lsd_10:
    s_waitcnt lgkmcnt(0)
    v_pk_add_f32 v[64:65], v[64:65], v[72:73]
    v_pk_add_f32 v[66:67], v[66:67], v[74:75]
    v_pk_add_f32 v[68:69], v[68:69], v[76:77]
    v_pk_add_f32 v[70:71], v[70:71], v[78:79]
    v_cndmask_b32 v71, v71, 0, s[48:49]
    v_cvt_pk_bf16_f32 v72, v64, v65
    v_cvt_pk_bf16_f32 v73, v66, v67
    v_cvt_pk_bf16_f32 v74, v68, v69
    v_cvt_pk_bf16_f32 v75, v70, v71
    ds_write_b64 v234, v[72:73]
    s_mov_b32 exec_hi, 0
    ds_write_b64 v234, v[74:75] offset:32
    s_mov_b32 exec_hi, -1
    v_mov_b32 v10, s58
    v_mov_b32 v11, 1
    s_mov_b64 exec, 1
    ds_add_u32 v10, v11 offset:40
    s_mov_b64 exec, -1
    buffer_load_dwordx4 v[20:23], v231, s[20:23], 0 offen sc1
    buffer_load_dwordx4 v[24:27], v231, s[20:23], 0 offen offset:64 sc1
    buffer_load_dword v28, v232, s[20:23], 0 offen offset:512 sc1
    v_and_b32 v5, 15, v1
    v_lshlrev_b32 v5, 3, v5
    s_lshl_b32 s41, s31, 8
    s_add_u32 s41, s41, 6029440
    buffer_load_dword v29, v5, s[20:23], s41 offen sc1
    v_mov_b32 v12, 0
    v_mov_b32 v13, 0
    v_mov_b32 v14, 0
    v_mov_b32 v15, 0
    v_mov_b32 v10, s58
    s_mov_b32 s91, 0
Ls_11:
    ds_read_b32 v11, v10 offset:40
    ds_read_u16 v160, v128
    ds_read_u16 v161, v129
    ds_read_u16 v162, v130
    ds_read_u16 v163, v131
    ds_read_u16 v164, v132
    ds_read_u16 v165, v133
    ds_read_u16 v166, v134
    ds_read_u16 v167, v135
    ds_read_u16 v168, v136
    ds_read_u16 v169, v137
    ds_read_u16 v170, v138
    s_add_u32 s91, s91, 1
    s_cmp_gt_u32 s91, 0x40000
    s_cbranch_scc1 Lsd_12
    s_waitcnt lgkmcnt(11)
    v_readfirstlane_b32 s90, v11
    s_nop 0
    s_cmp_lt_u32 s90, 2
    s_cbranch_scc1 Ls_11
Lsd_12:
    ds_read_u16 v172, v140
    ds_read_u16 v173, v141
    ds_read_u16 v174, v142
    ds_read_u16 v175, v143
    s_waitcnt lgkmcnt(8)
    ds_read_u16 v176, v144
    ds_read_u16 v177, v145
    ds_read_u16 v178, v146
    ds_read_u16 v179, v147
    ds_read_u16 v180, v148
    ds_read_u16 v181, v149
    ds_read_u16 v182, v150
    s_waitcnt lgkmcnt(11)
    v_lshl_or_b32 v88, v164, 16, v163
    v_lshl_or_b32 v89, v166, 16, v165
    v_lshl_or_b32 v90, v168, 16, v167
    v_lshl_or_b32 v91, v170, 16, v169
    v_lshl_or_b32 v92, v163, 16, v162
    v_lshl_or_b32 v93, v165, 16, v164
    v_lshl_or_b32 v94, v167, 16, v166
    v_lshl_or_b32 v95, v169, 16, v168
    v_lshl_or_b32 v96, v162, 16, v161
    v_lshl_or_b32 v97, v164, 16, v163
    v_lshl_or_b32 v98, v166, 16, v165
    v_lshl_or_b32 v99, v168, 16, v167
    v_lshl_or_b32 v100, v161, 16, v160
    v_lshl_or_b32 v101, v163, 16, v162
    v_lshl_or_b32 v102, v165, 16, v164
    v_lshl_or_b32 v103, v167, 16, v166
    ds_write_b128 v244, v[88:91] offset:0
    ds_write_b128 v244, v[92:95] offset:4160
    ds_write_b128 v244, v[96:99] offset:8320
    ds_write_b128 v244, v[100:103] offset:12480
    s_waitcnt lgkmcnt(4)
    v_lshl_or_b32 v104, v176, 16, v175
    v_lshl_or_b32 v105, v178, 16, v177
    v_lshl_or_b32 v106, v180, 16, v179
    v_lshl_or_b32 v107, v182, 16, v181
    ds_write_b128 v244, v[104:107] offset:1024
    v_lshl_or_b32 v108, v175, 16, v174
    v_lshl_or_b32 v109, v177, 16, v176
    v_lshl_or_b32 v110, v179, 16, v178
    v_lshl_or_b32 v111, v181, 16, v180
    ds_write_b128 v244, v[108:111] offset:5184
    v_lshl_or_b32 v112, v174, 16, v173
    v_lshl_or_b32 v113, v176, 16, v175
    v_lshl_or_b32 v114, v178, 16, v177
    v_lshl_or_b32 v115, v180, 16, v179
    ds_write_b128 v244, v[112:115] offset:9344
    v_lshl_or_b32 v116, v173, 16, v172
    v_lshl_or_b32 v117, v175, 16, v174
    v_lshl_or_b32 v118, v177, 16, v176
    v_lshl_or_b32 v119, v179, 16, v178
    ds_write_b128 v244, v[116:119] offset:13504
    s_mov_b64 exec, 0xffff
    ds_write_b128 v246, v[12:15] offset:4096
    s_mov_b64 exec, -1
    s_waitcnt vmcnt(0)
    s_getreg_b32 s41, hwreg(HW_REG_XCC_ID)
    s_and_b32 s41, s41, 15
    s_lshl_b32 s41, s41, 4
    s_xor_b32 s41, s41, s33
    v_cmp_ne_u32 vcc, s41, v29
    s_nop 0
    s_cmp_eq_u64 vcc, 0
    s_cselect_b32 s95, 1, 0
    s_cmp_ge_u32 s30, 4
    s_cselect_b32 s95, 1, s95
    s_cmp_eq_u32 s95, 1
    s_cbranch_scc1 L_a_nug
    s_mov_b32 s94, 16777216
    ds_read_b64_tr_b16 v[192:193], v243 offset:0
    ds_read_b64_tr_b16 v[194:195], v243 offset:512
    ds_read_b64_tr_b16 v[196:197], v243 offset:1024
    ds_read_b64_tr_b16 v[198:199], v243 offset:1536
    ds_read_b64_tr_b16 v[202:203], v243 offset:2048
    ds_read_b64_tr_b16 v[204:205], v243 offset:2560
    ds_read_b64_tr_b16 v[206:207], v243 offset:3072
    ds_read_b64_tr_b16 v[208:209], v243 offset:3584
    s_waitcnt lgkmcnt(4)
    buffer_store_dwordx4 v[192:195], v241, s[20:23], s94 offen offset:0 sc1
    buffer_store_dwordx4 v[196:199], v241, s[20:23], s94 offen offset:64 sc1
    v_bitop3_b32 v200, v192, v193, s33 bitop3:0x96
    v_bitop3_b32 v200, v200, v194, v195 bitop3:0x96
    v_bitop3_b32 v200, v200, v196, v197 bitop3:0x96
    v_bitop3_b32 v200, v200, v198, v199 bitop3:0x96
    v_mov_b32 v201, v200
    buffer_store_dwordx2 v[200:201], v242, s[20:23], s94 offen offset:512 sc1
    s_waitcnt lgkmcnt(0)
    buffer_store_dwordx4 v[202:205], v241, s[20:23], s94 offen offset:640 sc1
    buffer_store_dwordx4 v[206:209], v241, s[20:23], s94 offen offset:704 sc1
    v_bitop3_b32 v210, v202, v203, s33 bitop3:0x96
    v_bitop3_b32 v210, v210, v204, v205 bitop3:0x96
    v_bitop3_b32 v210, v210, v206, v207 bitop3:0x96
    v_bitop3_b32 v210, v210, v208, v209 bitop3:0x96
    v_mov_b32 v211, v210
    buffer_store_dwordx2 v[210:211], v242, s[20:23], s94 offen offset:1152 sc1
L_a_nug:
    s_mov_b32 s92, 0
    s_mov_b32 s94, 0
    s_branch L_a_uchk
L_a_upoll:
    s_add_u32 s92, s92, 1
    s_cmp_gt_u32 s92, 0x4000
    s_cbranch_scc1 L_a_udone
    s_cmp_gt_u32 s92, 48
    s_cselect_b32 s93, 16777216, 0
    s_xor_b32 s94, s94, s93
    s_sleep 2
    buffer_load_dwordx4 v[20:23], v231, s[20:23], s94 offen sc1
    buffer_load_dwordx4 v[24:27], v231, s[20:23], s94 offen offset:64 sc1
    buffer_load_dword v28, v232, s[20:23], s94 offen offset:512 sc1
    s_waitcnt vmcnt(0)
L_a_uchk:
    v_bitop3_b32 v10, v20, v21, v22 bitop3:0x96
    v_bitop3_b32 v10, v10, v23, v24 bitop3:0x96
    v_bitop3_b32 v10, v10, v25, v26 bitop3:0x96
    v_bitop3_b32 v10, v10, v27, v28 bitop3:0x96
    v_cmp_ne_u32 vcc, s33, v10
    s_nop 0
    s_cbranch_vccnz L_a_upoll
L_a_udone:
    s_waitcnt vmcnt(0)
    s_cmp_lt_u32 s30, 4
    s_cbranch_scc0 L_a_ntb
    s_and_b32 s90, s3, 15
    s_lshl_b32 s90, s90, 2
    s_and_b32 s91, s30, 3
    s_add_u32 s90, s90, s91
    v_lshlrev_b32 v10, 7, v1
    s_lshl_b32 s91, s31, 6
    s_add_u32 s91, s91, s90
    s_lshl_b32 s92, s91, 12
    s_add_u32 s92, s92, 1048576
    s_mov_b32 exec_hi, 0
    buffer_load_dword v254, v10, s[20:23], s92 offen sc1
    s_lshl_b32 s92, s91, 9
    s_add_u32 s92, s92, 524288
    s_mov_b32 exec_lo, 15
    buffer_load_dword v254, v10, s[20:23], s92 offen sc1
    s_mul_i32 s90, s90, 7168
    s_add_u32 s90, s90, 5505024
    s_mov_b32 exec_lo, -1
    s_mov_b32 exec_hi, 0xffffff
    buffer_load_dword v254, v10, s[20:23], s90 offen sc1
    s_mov_b64 exec, -1
L_a_ntb:
    v_and_b32 v5, 15, v1
    v_lshlrev_b32 v5, 3, v5
    s_lshl_b32 s41, s31, 8
    s_add_u32 s41, s41, 6029440
    buffer_load_dword v251, v5, s[20:23], s41 offen sc1
    ds_write_b128 v233, v[20:23]
    ds_write_b128 v233, v[24:27] offset:16
    v_add_u32 v10, 4584, v233
    ds_write2_b64 v10, v[20:21], v[22:23] offset0:0 offset1:1
    ds_write2_b64 v10, v[24:25], v[26:27] offset0:2 offset1:3
    v_mov_b32 v10, s86
    v_mov_b32 v11, 1
    s_mov_b64 exec, 1
    ds_add_u32 v10, v11 offset:48
    s_mov_b64 exec, -1
    v_mov_b32 v64, 0
    v_mov_b32 v65, 0
    v_mov_b32 v66, 0
    v_mov_b32 v67, 0
    v_mov_b32 v68, 0
    v_mov_b32 v69, 0
    v_mov_b32 v70, 0
    v_mov_b32 v71, 0
    v_mov_b32 v72, 0
    v_mov_b32 v73, 0
    v_mov_b32 v74, 0
    v_mov_b32 v75, 0
    v_mov_b32 v76, 0
    v_mov_b32 v77, 0
    v_mov_b32 v78, 0
    v_mov_b32 v79, 0
    v_mov_b32 v80, 0
    v_mov_b32 v81, 0
    v_mov_b32 v82, 0
    v_mov_b32 v83, 0
    s_setprio 1
    s_cmp_eq_u32 s38, 0
    s_cbranch_scc0 L_a_conv1
    v_mov_b32 v10, s86
    s_mov_b32 s91, 0
Ls_13:
    ds_read_b32 v11, v10 offset:48
    ds_read_b128 v[160:163], v236 offset:0
    ds_read_b128 v[96:99], v235 offset:3584
    ds_read_b128 v[164:167], v236 offset:512
    ds_read_b128 v[100:103], v235 offset:3072
    ds_read_b128 v[168:171], v236 offset:1024
    ds_read_b128 v[104:107], v235 offset:2560
    ds_read_b128 v[172:175], v236 offset:1536
    ds_read_b128 v[108:111], v235 offset:2048
    ds_read_b128 v[176:179], v236 offset:2048
    ds_read_b128 v[112:115], v235 offset:1536
    ds_read_b128 v[180:183], v236 offset:2560
    ds_read_b128 v[116:119], v235 offset:1024
    s_add_u32 s91, s91, 1
    s_cmp_gt_u32 s91, 0x40000
    s_cbranch_scc1 Lsd_14
    s_waitcnt lgkmcnt(12)
    v_readfirstlane_b32 s90, v11
    s_nop 0
    s_cmp_lt_u32 s90, 4
    s_cbranch_scc1 Ls_13
Lsd_14:
    ds_read_b128 v[184:187], v236 offset:3072
    ds_read_b128 v[120:123], v235 offset:512
    ds_read_b128 v[188:191], v236 offset:3584
    ds_read_b128 v[124:127], v235 offset:0
    v_subrev_u32 v235, 64, v235
    v_subrev_u32 v236, 64, v236
    s_mov_b32 s91, 0
L_c0_loop:
    s_waitcnt lgkmcnt(0)
    ds_read_b128 v[192:195], v236 offset:0
    v_mfma_f32_16x16x32_bf16 v[72:75], v[100:103], v[164:167], v[72:75]
    ds_read_b128 v[128:131], v235 offset:3584
    v_mfma_f32_16x16x32_bf16 v[72:75], v[96:99], v[168:171], v[72:75]
    ds_read_b128 v[196:199], v236 offset:512
    v_mfma_f32_16x16x32_bf16 v[72:75], v[104:107], v[160:163], v[72:75]
    ds_read_b128 v[132:135], v235 offset:3072
    v_mfma_f32_16x16x32_bf16 v[68:71], v[108:111], v[172:175], v[68:71]
    ds_read_b128 v[200:203], v236 offset:1024
    v_mfma_f32_16x16x32_bf16 v[64:67], v[108:111], v[176:179], v[64:67]
    ds_read_b128 v[136:139], v235 offset:2560
    v_mfma_f32_16x16x32_bf16 v[64:67], v[112:115], v[172:175], v[64:67]
    ds_read_b128 v[204:207], v236 offset:1536
    v_mfma_f32_16x16x32_bf16 v[68:71], v[104:107], v[176:179], v[68:71]
    ds_read_b128 v[140:143], v235 offset:2048
    v_mfma_f32_16x16x32_bf16 v[68:71], v[112:115], v[168:171], v[68:71]
    ds_read_b128 v[208:211], v236 offset:2048
    v_mfma_f32_16x16x32_bf16 v[64:67], v[104:107], v[180:183], v[64:67]
    ds_read_b128 v[144:147], v235 offset:1536
    v_mfma_f32_16x16x32_bf16 v[64:67], v[116:119], v[168:171], v[64:67]
    ds_read_b128 v[212:215], v236 offset:2560
    v_mfma_f32_16x16x32_bf16 v[68:71], v[100:103], v[180:183], v[68:71]
    ds_read_b128 v[148:151], v235 offset:1024
    v_mfma_f32_16x16x32_bf16 v[68:71], v[116:119], v[164:167], v[68:71]
    ds_read_b128 v[216:219], v236 offset:3072
    v_mfma_f32_16x16x32_bf16 v[64:67], v[100:103], v[184:187], v[64:67]
    ds_read_b128 v[152:155], v235 offset:512
    v_mfma_f32_16x16x32_bf16 v[64:67], v[120:123], v[164:167], v[64:67]
    ds_read_b128 v[220:223], v236 offset:3584
    v_mfma_f32_16x16x32_bf16 v[68:71], v[96:99], v[184:187], v[68:71]
    ds_read_b128 v[156:159], v235 offset:0
    v_mfma_f32_16x16x32_bf16 v[68:71], v[120:123], v[160:163], v[68:71]
    v_mfma_f32_16x16x32_bf16 v[64:67], v[96:99], v[188:191], v[64:67]
    v_mfma_f32_16x16x32_bf16 v[64:67], v[124:127], v[160:163], v[64:67]
    v_subrev_u32 v235, 64, v235
    v_subrev_u32 v236, 64, v236
    s_waitcnt lgkmcnt(0)
    s_cmp_eq_u32 s91, 3
    s_cbranch_scc1 L_c0_tail
    ds_read_b128 v[160:163], v236 offset:0
    v_mfma_f32_16x16x32_bf16 v[72:75], v[132:135], v[196:199], v[72:75]
    ds_read_b128 v[96:99], v235 offset:3584
    v_mfma_f32_16x16x32_bf16 v[72:75], v[128:131], v[200:203], v[72:75]
    ds_read_b128 v[164:167], v236 offset:512
    v_mfma_f32_16x16x32_bf16 v[72:75], v[136:139], v[192:195], v[72:75]
    ds_read_b128 v[100:103], v235 offset:3072
    v_mfma_f32_16x16x32_bf16 v[68:71], v[140:143], v[204:207], v[68:71]
    ds_read_b128 v[168:171], v236 offset:1024
    v_mfma_f32_16x16x32_bf16 v[64:67], v[140:143], v[208:211], v[64:67]
    ds_read_b128 v[104:107], v235 offset:2560
    v_mfma_f32_16x16x32_bf16 v[64:67], v[144:147], v[204:207], v[64:67]
    ds_read_b128 v[172:175], v236 offset:1536
    v_mfma_f32_16x16x32_bf16 v[68:71], v[136:139], v[208:211], v[68:71]
    ds_read_b128 v[108:111], v235 offset:2048
    v_mfma_f32_16x16x32_bf16 v[68:71], v[144:147], v[200:203], v[68:71]
    ds_read_b128 v[176:179], v236 offset:2048
    v_mfma_f32_16x16x32_bf16 v[64:67], v[136:139], v[212:215], v[64:67]
    ds_read_b128 v[112:115], v235 offset:1536
    v_mfma_f32_16x16x32_bf16 v[64:67], v[148:151], v[200:203], v[64:67]
    ds_read_b128 v[180:183], v236 offset:2560
    v_mfma_f32_16x16x32_bf16 v[68:71], v[132:135], v[212:215], v[68:71]
    ds_read_b128 v[116:119], v235 offset:1024
    v_mfma_f32_16x16x32_bf16 v[68:71], v[148:151], v[196:199], v[68:71]
    ds_read_b128 v[184:187], v236 offset:3072
    v_mfma_f32_16x16x32_bf16 v[64:67], v[132:135], v[216:219], v[64:67]
    ds_read_b128 v[120:123], v235 offset:512
    v_mfma_f32_16x16x32_bf16 v[64:67], v[152:155], v[196:199], v[64:67]
    ds_read_b128 v[188:191], v236 offset:3584
    v_mfma_f32_16x16x32_bf16 v[68:71], v[128:131], v[216:219], v[68:71]
    ds_read_b128 v[124:127], v235 offset:0
    v_mfma_f32_16x16x32_bf16 v[68:71], v[152:155], v[192:195], v[68:71]
    v_mfma_f32_16x16x32_bf16 v[64:67], v[128:131], v[220:223], v[64:67]
    v_mfma_f32_16x16x32_bf16 v[64:67], v[156:159], v[192:195], v[64:67]
    v_subrev_u32 v235, 64, v235
    v_subrev_u32 v236, 64, v236
    s_add_u32 s91, s91, 1
    s_branch L_c0_loop
L_c0_tail:
    v_mfma_f32_16x16x32_bf16 v[72:75], v[132:135], v[196:199], v[72:75]
    s_xor_b32 s89, s33, 0x5a5a0000
    s_xor_b32 s92, s86, 128
    v_mfma_f32_16x16x32_bf16 v[72:75], v[128:131], v[200:203], v[72:75]
    v_cmp_lt_u32 s[56:57], 31, v1
    s_mov_b32 s94, 33554432
    v_mfma_f32_16x16x32_bf16 v[72:75], v[136:139], v[192:195], v[72:75]
    v_mov_b32 v9, 17920
    v_mov_b32 v10, 15360
    v_mfma_f32_16x16x32_bf16 v[68:71], v[140:143], v[204:207], v[68:71]
    v_cndmask_b32 v9, v9, v10, s[56:57]
    v_add_u32 v26, v9, v239
    v_mfma_f32_16x16x32_bf16 v[64:67], v[140:143], v[208:211], v[64:67]
    v_add_u32 v27, v9, v240
    v_mov_b32 v9, 5120
    v_mfma_f32_16x16x32_bf16 v[64:67], v[144:147], v[204:207], v[64:67]
    v_mov_b32 v10, 5120
    v_cndmask_b32 v9, v9, v10, s[56:57]
    v_mfma_f32_16x16x32_bf16 v[68:71], v[136:139], v[208:211], v[68:71]
    v_add_u32 v34, v9, v239
    v_add_u32 v35, v9, v240
    v_mfma_f32_16x16x32_bf16 v[68:71], v[144:147], v[200:203], v[68:71]
    v_mfma_f32_16x16x32_bf16 v[64:67], v[136:139], v[212:215], v[64:67]
    v_mfma_f32_16x16x32_bf16 v[64:67], v[148:151], v[200:203], v[64:67]
    v_mfma_f32_16x16x32_bf16 v[68:71], v[132:135], v[212:215], v[68:71]
    v_mfma_f32_16x16x32_bf16 v[68:71], v[148:151], v[196:199], v[68:71]
    v_mfma_f32_16x16x32_bf16 v[64:67], v[132:135], v[216:219], v[64:67]
    v_mfma_f32_16x16x32_bf16 v[64:67], v[152:155], v[196:199], v[64:67]
    v_mfma_f32_16x16x32_bf16 v[68:71], v[128:131], v[216:219], v[68:71]
    v_mfma_f32_16x16x32_bf16 v[68:71], v[152:155], v[192:195], v[68:71]
    v_mfma_f32_16x16x32_bf16 v[64:67], v[128:131], v[220:223], v[64:67]
    v_mfma_f32_16x16x32_bf16 v[64:67], v[156:159], v[192:195], v[64:67]
    s_waitcnt vmcnt(0)
    s_getreg_b32 s41, hwreg(HW_REG_XCC_ID)
    s_and_b32 s41, s41, 15
    s_lshl_b32 s41, s41, 4
    s_xor_b32 s41, s41, s33
    v_cmp_ne_u32 vcc, s41, v251
    s_nop 0
    s_cmp_eq_u64 vcc, 0
    s_cselect_b32 s93, 1, 0
    v_cvt_pk_bf16_f32 v44, v64, v65
    v_cvt_pk_bf16_f32 v45, v66, v67
    ds_write_b64 v237, v[44:45] offset:0
    v_cvt_pk_bf16_f32 v46, v68, v69
    v_cvt_pk_bf16_f32 v47, v70, v71
    ds_write_b64 v237, v[46:47] offset:512
    ds_read_b128 v[20:23], v238
    v_cvt_pk_bf16_f32 v48, v72, v73
    v_cvt_pk_bf16_f32 v49, v74, v75
    ds_write_b64 v237, v[48:49] offset:0
    ds_read_b128 v[28:31], v238
    v_mov_b32 v10, s92
    s_mov_b32 s91, 0
Lw_15:
    ds_read_b32 v11, v10 offset:48
    s_add_u32 s91, s91, 1
    s_cmp_gt_u32 s91, 0x40000
    s_cbranch_scc1 Lwd_16
    s_waitcnt lgkmcnt(0)
    v_readfirstlane_b32 s90, v11
    s_nop 0
    s_cmp_ge_u32 s90, 4
    s_cbranch_scc1 Lwd_16
    s_sleep 1
    s_branch Lw_15
Lwd_16:
    s_waitcnt lgkmcnt(0)
    buffer_store_dwordx4 v[20:23], v26, s[20:23], 0 offen
    v_bitop3_b32 v24, v20, v21, v22 bitop3:0x96
    v_bitop3_b32 v24, v24, v23, s89 bitop3:0x96
    buffer_store_dword v24, v27, s[20:23], 0 offen offset:128
    s_mov_b32 exec_hi, 0
    buffer_store_dwordx4 v[28:31], v34, s[20:23], 0 offen
    v_bitop3_b32 v32, v28, v29, v30 bitop3:0x96
    v_bitop3_b32 v32, v32, v31, s89 bitop3:0x96
    buffer_store_dword v32, v35, s[20:23], 0 offen offset:128
    s_mov_b32 exec_hi, -1
    s_cmp_eq_u32 s93, 1
    s_cbranch_scc1 L_c0_nog
    buffer_store_dwordx4 v[20:23], v26, s[20:23], s94 offen sc1
    buffer_store_dword v24, v27, s[20:23], s94 offen offset:128 sc1
    s_mov_b32 exec_hi, 0
    buffer_store_dwordx4 v[28:31], v34, s[20:23], s94 offen sc1
    buffer_store_dword v32, v35, s[20:23], s94 offen offset:128 sc1
    s_mov_b32 exec_hi, -1
L_c0_nog:
    s_branch L_a_convd
L_a_conv1:
    v_mov_b32 v10, s86
    s_mov_b32 s91, 0
Ls_17:
    ds_read_b32 v11, v10 offset:48
    ds_read_b128 v[160:163], v236 offset:0
    ds_read_b128 v[96:99], v235 offset:3584
    ds_read_b128 v[164:167], v236 offset:512
    ds_read_b128 v[100:103], v235 offset:3072
    ds_read_b128 v[168:171], v236 offset:1024
    ds_read_b128 v[104:107], v235 offset:2560
    ds_read_b128 v[172:175], v236 offset:1536
    ds_read_b128 v[108:111], v235 offset:2048
    ds_read_b128 v[176:179], v236 offset:2048
    ds_read_b128 v[112:115], v235 offset:1536
    ds_read_b128 v[180:183], v236 offset:2560
    ds_read_b128 v[116:119], v235 offset:1024
    s_add_u32 s91, s91, 1
    s_cmp_gt_u32 s91, 0x40000
    s_cbranch_scc1 Lsd_18
    s_waitcnt lgkmcnt(12)
    v_readfirstlane_b32 s90, v11
    s_nop 0
    s_cmp_lt_u32 s90, 4
    s_cbranch_scc1 Ls_17
Lsd_18:
    v_subrev_u32 v235, 64, v235
    v_subrev_u32 v236, 64, v236
    s_mov_b32 s91, 0
L_c1_loop:
    s_waitcnt lgkmcnt(0)
    ds_read_b128 v[192:195], v236 offset:0
    v_mfma_f32_16x16x32_bf16 v[80:83], v[96:99], v[160:163], v[80:83]
    ds_read_b128 v[128:131], v235 offset:3584
    v_mfma_f32_16x16x32_bf16 v[76:79], v[96:99], v[164:167], v[76:79]
    ds_read_b128 v[196:199], v236 offset:512
    v_mfma_f32_16x16x32_bf16 v[76:79], v[100:103], v[160:163], v[76:79]
    ds_read_b128 v[132:135], v235 offset:3072
    v_mfma_f32_16x16x32_bf16 v[68:71], v[104:107], v[168:171], v[68:71]
    ds_read_b128 v[200:203], v236 offset:1024
    v_mfma_f32_16x16x32_bf16 v[72:75], v[100:103], v[168:171], v[72:75]
    ds_read_b128 v[136:139], v235 offset:2560
    v_mfma_f32_16x16x32_bf16 v[72:75], v[104:107], v[164:167], v[72:75]
    ds_read_b128 v[204:207], v236 offset:1536
    v_mfma_f32_16x16x32_bf16 v[64:67], v[104:107], v[172:175], v[64:67]
    ds_read_b128 v[140:143], v235 offset:2048
    v_mfma_f32_16x16x32_bf16 v[64:67], v[108:111], v[168:171], v[64:67]
    ds_read_b128 v[208:211], v236 offset:2048
    v_mfma_f32_16x16x32_bf16 v[68:71], v[100:103], v[172:175], v[68:71]
    ds_read_b128 v[144:147], v235 offset:1536
    v_mfma_f32_16x16x32_bf16 v[68:71], v[108:111], v[164:167], v[68:71]
    ds_read_b128 v[212:215], v236 offset:2560
    v_mfma_f32_16x16x32_bf16 v[72:75], v[96:99], v[172:175], v[72:75]
    ds_read_b128 v[148:151], v235 offset:1024
    v_mfma_f32_16x16x32_bf16 v[72:75], v[108:111], v[160:163], v[72:75]
    v_mfma_f32_16x16x32_bf16 v[64:67], v[100:103], v[176:179], v[64:67]
    v_mfma_f32_16x16x32_bf16 v[64:67], v[112:115], v[164:167], v[64:67]
    v_mfma_f32_16x16x32_bf16 v[68:71], v[96:99], v[176:179], v[68:71]
    v_mfma_f32_16x16x32_bf16 v[68:71], v[112:115], v[160:163], v[68:71]
    v_mfma_f32_16x16x32_bf16 v[64:67], v[96:99], v[180:183], v[64:67]
    v_mfma_f32_16x16x32_bf16 v[64:67], v[116:119], v[160:163], v[64:67]
    v_subrev_u32 v235, 64, v235
    v_subrev_u32 v236, 64, v236
    s_waitcnt lgkmcnt(0)
    s_cmp_eq_u32 s91, 3
    s_cbranch_scc1 L_c1_tail
    ds_read_b128 v[160:163], v236 offset:0
    v_mfma_f32_16x16x32_bf16 v[80:83], v[128:131], v[192:195], v[80:83]
    ds_read_b128 v[96:99], v235 offset:3584
    v_mfma_f32_16x16x32_bf16 v[76:79], v[128:131], v[196:199], v[76:79]
    ds_read_b128 v[164:167], v236 offset:512
    v_mfma_f32_16x16x32_bf16 v[76:79], v[132:135], v[192:195], v[76:79]
    ds_read_b128 v[100:103], v235 offset:3072
    v_mfma_f32_16x16x32_bf16 v[68:71], v[136:139], v[200:203], v[68:71]
    ds_read_b128 v[168:171], v236 offset:1024
    v_mfma_f32_16x16x32_bf16 v[72:75], v[132:135], v[200:203], v[72:75]
    ds_read_b128 v[104:107], v235 offset:2560
    v_mfma_f32_16x16x32_bf16 v[72:75], v[136:139], v[196:199], v[72:75]
    ds_read_b128 v[172:175], v236 offset:1536
    v_mfma_f32_16x16x32_bf16 v[64:67], v[136:139], v[204:207], v[64:67]
    ds_read_b128 v[108:111], v235 offset:2048
    v_mfma_f32_16x16x32_bf16 v[64:67], v[140:143], v[200:203], v[64:67]
    ds_read_b128 v[176:179], v236 offset:2048
    v_mfma_f32_16x16x32_bf16 v[68:71], v[132:135], v[204:207], v[68:71]
    ds_read_b128 v[112:115], v235 offset:1536
    v_mfma_f32_16x16x32_bf16 v[68:71], v[140:143], v[196:199], v[68:71]
    ds_read_b128 v[180:183], v236 offset:2560
    v_mfma_f32_16x16x32_bf16 v[72:75], v[128:131], v[204:207], v[72:75]
    ds_read_b128 v[116:119], v235 offset:1024
    v_mfma_f32_16x16x32_bf16 v[72:75], v[140:143], v[192:195], v[72:75]
    v_mfma_f32_16x16x32_bf16 v[64:67], v[132:135], v[208:211], v[64:67]
    v_mfma_f32_16x16x32_bf16 v[64:67], v[144:147], v[196:199], v[64:67]
    v_mfma_f32_16x16x32_bf16 v[68:71], v[128:131], v[208:211], v[68:71]
    v_mfma_f32_16x16x32_bf16 v[68:71], v[144:147], v[192:195], v[68:71]
    v_mfma_f32_16x16x32_bf16 v[64:67], v[128:131], v[212:215], v[64:67]
    v_mfma_f32_16x16x32_bf16 v[64:67], v[148:151], v[192:195], v[64:67]
    v_subrev_u32 v235, 64, v235
    v_subrev_u32 v236, 64, v236
    s_add_u32 s91, s91, 1
    s_branch L_c1_loop
L_c1_tail:
    v_mfma_f32_16x16x32_bf16 v[80:83], v[128:131], v[192:195], v[80:83]
    s_xor_b32 s89, s33, 0x5a5a0000
    s_xor_b32 s92, s86, 128
    v_mfma_f32_16x16x32_bf16 v[76:79], v[128:131], v[196:199], v[76:79]
    v_cmp_lt_u32 s[56:57], 31, v1
    s_mov_b32 s94, 33554432
    v_mfma_f32_16x16x32_bf16 v[76:79], v[132:135], v[192:195], v[76:79]
    v_mov_b32 v9, 12800
    v_mov_b32 v10, 10240
    v_mfma_f32_16x16x32_bf16 v[68:71], v[136:139], v[200:203], v[68:71]
    v_cndmask_b32 v9, v9, v10, s[56:57]
    v_add_u32 v26, v9, v239
    v_mfma_f32_16x16x32_bf16 v[72:75], v[132:135], v[200:203], v[72:75]
    v_add_u32 v27, v9, v240
    v_mov_b32 v9, 7680
    v_mfma_f32_16x16x32_bf16 v[72:75], v[136:139], v[196:199], v[72:75]
    v_mov_b32 v10, 2560
    v_cndmask_b32 v9, v9, v10, s[56:57]
    v_mfma_f32_16x16x32_bf16 v[64:67], v[136:139], v[204:207], v[64:67]
    v_add_u32 v34, v9, v239
    v_add_u32 v35, v9, v240
    v_mfma_f32_16x16x32_bf16 v[64:67], v[140:143], v[200:203], v[64:67]
    v_mov_b32 v9, 0
    v_mov_b32 v10, 0
    v_mfma_f32_16x16x32_bf16 v[68:71], v[132:135], v[204:207], v[68:71]
    v_cndmask_b32 v9, v9, v10, s[56:57]
    v_add_u32 v42, v9, v239
    v_mfma_f32_16x16x32_bf16 v[68:71], v[140:143], v[196:199], v[68:71]
    v_add_u32 v43, v9, v240
    v_mfma_f32_16x16x32_bf16 v[72:75], v[128:131], v[204:207], v[72:75]
    v_mfma_f32_16x16x32_bf16 v[72:75], v[140:143], v[192:195], v[72:75]
    v_mfma_f32_16x16x32_bf16 v[64:67], v[132:135], v[208:211], v[64:67]
    v_mfma_f32_16x16x32_bf16 v[64:67], v[144:147], v[196:199], v[64:67]
    v_mfma_f32_16x16x32_bf16 v[68:71], v[128:131], v[208:211], v[68:71]
    v_mfma_f32_16x16x32_bf16 v[68:71], v[144:147], v[192:195], v[68:71]
    v_mfma_f32_16x16x32_bf16 v[64:67], v[128:131], v[212:215], v[64:67]
    v_mfma_f32_16x16x32_bf16 v[64:67], v[148:151], v[192:195], v[64:67]
    s_waitcnt vmcnt(0)
    s_getreg_b32 s41, hwreg(HW_REG_XCC_ID)
    s_and_b32 s41, s41, 15
    s_lshl_b32 s41, s41, 4
    s_xor_b32 s41, s41, s33
    v_cmp_ne_u32 vcc, s41, v251
    s_nop 0
    s_cmp_eq_u64 vcc, 0
    s_cselect_b32 s93, 1, 0
    v_cvt_pk_bf16_f32 v44, v64, v65
    v_cvt_pk_bf16_f32 v45, v66, v67
    ds_write_b64 v237, v[44:45] offset:0
    v_cvt_pk_bf16_f32 v46, v68, v69
    v_cvt_pk_bf16_f32 v47, v70, v71
    ds_write_b64 v237, v[46:47] offset:512
    ds_read_b128 v[20:23], v238
    v_cvt_pk_bf16_f32 v48, v72, v73
    v_cvt_pk_bf16_f32 v49, v74, v75
    ds_write_b64 v237, v[48:49] offset:0
    v_cvt_pk_bf16_f32 v50, v76, v77
    v_cvt_pk_bf16_f32 v51, v78, v79
    ds_write_b64 v237, v[50:51] offset:512
    ds_read_b128 v[28:31], v238
    v_cvt_pk_bf16_f32 v52, v80, v81
    v_cvt_pk_bf16_f32 v53, v82, v83
    ds_write_b64 v237, v[52:53] offset:0
    ds_read_b128 v[36:39], v238
    v_mov_b32 v10, s92
    s_mov_b32 s91, 0
Lw_19:
    ds_read_b32 v11, v10 offset:48
    s_add_u32 s91, s91, 1
    s_cmp_gt_u32 s91, 0x40000
    s_cbranch_scc1 Lwd_20
    s_waitcnt lgkmcnt(0)
    v_readfirstlane_b32 s90, v11
    s_nop 0
    s_cmp_ge_u32 s90, 4
    s_cbranch_scc1 Lwd_20
    s_sleep 1
    s_branch Lw_19
Lwd_20:
    s_waitcnt lgkmcnt(0)
    buffer_store_dwordx4 v[20:23], v26, s[20:23], 0 offen
    v_bitop3_b32 v24, v20, v21, v22 bitop3:0x96
    v_bitop3_b32 v24, v24, v23, s89 bitop3:0x96
    buffer_store_dword v24, v27, s[20:23], 0 offen offset:128
    buffer_store_dwordx4 v[28:31], v34, s[20:23], 0 offen
    v_bitop3_b32 v32, v28, v29, v30 bitop3:0x96
    v_bitop3_b32 v32, v32, v31, s89 bitop3:0x96
    buffer_store_dword v32, v35, s[20:23], 0 offen offset:128
    s_mov_b32 exec_hi, 0
    buffer_store_dwordx4 v[36:39], v42, s[20:23], 0 offen
    v_bitop3_b32 v40, v36, v37, v38 bitop3:0x96
    v_bitop3_b32 v40, v40, v39, s89 bitop3:0x96
    buffer_store_dword v40, v43, s[20:23], 0 offen offset:128
    s_mov_b32 exec_hi, -1
    s_cmp_eq_u32 s93, 1
    s_cbranch_scc1 L_c1_nog
    buffer_store_dwordx4 v[20:23], v26, s[20:23], s94 offen sc1
    buffer_store_dword v24, v27, s[20:23], s94 offen offset:128 sc1
    buffer_store_dwordx4 v[28:31], v34, s[20:23], s94 offen sc1
    buffer_store_dword v32, v35, s[20:23], s94 offen offset:128 sc1
    s_mov_b32 exec_hi, 0
    buffer_store_dwordx4 v[36:39], v42, s[20:23], s94 offen sc1
    buffer_store_dword v40, v43, s[20:23], s94 offen offset:128 sc1
    s_mov_b32 exec_hi, -1
L_c1_nog:
L_a_convd:
    s_setprio 0
    v_mov_b32 v10, s86
    v_mov_b32 v11, 1
    s_mov_b64 exec, 1
    ds_add_u32 v10, v11 offset:56
    s_mov_b64 exec, -1
    s_mov_b32 s41, 14336
    v_mov_b32 v10, s86
    s_mov_b32 s91, 0
Lw_21:
    ds_read_b32 v11, v10 offset:56
    s_add_u32 s91, s91, 1
    s_cmp_gt_u32 s91, 0x40000
    s_cbranch_scc1 Lwd_22
    s_waitcnt lgkmcnt(0)
    v_readfirstlane_b32 s90, v11
    s_nop 0
    s_cmp_ge_u32 s90, 4
    s_cbranch_scc1 Lwd_22
    s_sleep 1
    s_branch Lw_21
Lwd_22:
    s_waitcnt lgkmcnt(0)
    s_mov_b32 s92, 0
    s_mov_b32 s94, 0
L_a_ypoll:
    s_add_u32 s92, s92, 1
    s_cmp_gt_u32 s92, 0x4000
    s_cbranch_scc1 L_a_ydone
    s_cmp_gt_u32 s92, 48
    s_cselect_b32 s93, 33554432, 0
    s_xor_b32 s94, s94, s93
    s_sleep 2
    s_add_u32 s95, s94, 163840
    buffer_load_dwordx4 v[20:23], v224, s[20:23], s94 offen sc1
    buffer_load_dwordx4 v[24:27], v224, s[20:23], s95 offen sc1
    buffer_load_dword v28, v225, s[20:23], s94 offen offset:128 sc1
    buffer_load_dword v30, v225, s[20:23], s95 offen offset:128 sc1
    s_waitcnt vmcnt(0)
    v_bitop3_b32 v10, v20, v21, v22 bitop3:0x96
    v_bitop3_b32 v11, v24, v25, v26 bitop3:0x96
    v_bitop3_b32 v10, v10, v23, v28 bitop3:0x96
    v_bitop3_b32 v11, v11, v27, v30 bitop3:0x96
    v_xor_b32 v10, s89, v10
    v_xor_b32 v11, s89, v11
    v_or_b32 v10, v10, v11
    v_cmp_ne_u32 vcc, 0, v10
    s_nop 0
    s_cbranch_vccnz L_a_ypoll
L_a_ydone:
    s_waitcnt vmcnt(0)
    ds_write_b128 v226, v[20:23]
    ds_write_b128 v226, v[24:27] offset:1024
    ds_read_b64_tr_b16 v[20:21], v227
    ds_read_b64_tr_b16 v[22:23], v227 offset:128
    ds_read_b64_tr_b16 v[24:25], v227 offset:1024
    ds_read_b64_tr_b16 v[26:27], v227 offset:1152
    s_waitcnt lgkmcnt(2)
    ds_write_b128 v228, v[20:23]
    s_waitcnt lgkmcnt(1)
    ds_write_b128 v228, v[24:27] offset:64
    ds_read_b128 v[28:31], v229
    ds_read_b128 v[32:35], v229 offset:1152
    s_waitcnt lgkmcnt(1)
    buffer_store_dwordx4 v[28:31], v230, s[96:99], 0 offen sc1
    s_waitcnt lgkmcnt(0)
    buffer_store_dwordx4 v[32:35], v230, s[96:99], s41 offen sc1
    s_endpgm
L_pack:
    s_cmp_ge_u32 s30, 4
    s_cbranch_scc0 L_p_p1
    s_and_b32 s45, s3, 15
    s_and_b32 s47, s30, 3
    s_add_u32 s47, s47, 4
    s_min_u32 s47, s47, 6
    v_mul_u32_u24 v14, 37, v1
    v_lshrrev_b32 v13, 9, v14
    v_mad_u32_u24 v12, v13, 7, v1
    v_lshlrev_b32 v12, 7, v12
    s_lshl_b32 s46, s47, 4
    s_add_u32 s46, s46, s45
    s_mul_i32 s46, s46, 10752
    v_add_u32 v12, s46, v12
    s_mov_b32 exec_hi, 0xffffff
    global_load_dword v254, v12, s[20:21] offset:896
    s_mov_b64 exec, -1
    v_mul_u32_u24 v13, 896, v1
    s_lshl_b32 s46, s31, 4
    s_add_u32 s46, s46, s45
    s_mul_i32 s46, s46, 14336
    s_lshl_b32 s47, s47, 7
    s_add_u32 s46, s46, s47
    v_add_u32 v13, s46, v13
    s_mov_b64 exec, 0xffff
    global_load_dword v254, v13, s[18:19]
    s_mov_b64 exec, -1
    v_lshrrev_b32 v13, 8, v14
    v_mad_u32_u24 v12, v13, 14, v1
    v_lshlrev_b32 v12, 7, v12
    s_lshl_b32 s45, s45, 2
    s_and_b32 s47, s30, 3
    s_add_u32 s45, s45, s47
    s_mul_i32 s45, s45, 18816
    v_add_u32 v12, s45, v12
    s_mov_b32 exec_hi, 0x1ffff
    global_load_dword v254, v12, s[20:21]
    s_mov_b64 exec, -1
L_p_p1:
    s_mov_b32 s12, s22
    s_and_b32 s13, s23, 0xffff
    s_mov_b32 s14, 401408
    s_mov_b32 s15, 0x00020000
    s_mov_b32 s20, s28
    s_and_b32 s21, s29, 0xffff
    s_mov_b32 s22, 268435456
    s_mov_b32 s23, 0x00020000
    s_and_b32 s45, s3, 15
    s_lshl_b32 s45, s45, 3
    s_add_u32 s45, s45, s30
    v_lshlrev_b32 v2, 4, v1
    v_lshlrev_b32 v3, 2, v1
    v_and_b32 v4, 3, v1
    v_bfe_u32 v6, v1, 2, 2
    v_lshrrev_b32 v16, 5, v1
    v_bfe_u32 v17, v1, 4, 1
    v_lshl_add_u32 v20, v16, 2, v6
    v_lshlrev_b32 v20, 6, v20
    v_lshl_add_u32 v20, v17, 5, v20
    v_lshl_add_u32 v20, v4, 3, v20
    v_add_u32 v20, s101, v20
    s_mul_hi_u32 s58, s45, 0x12492493
    s_mul_i32 s41, s58, 14
    s_sub_u32 s41, s45, s41
    s_lshl_b32 s41, s41, 2
    s_lshl_b32 s58, s58, 6
    s_mul_i32 s46, s45, 2304
    s_add_u32 s46, s46, 5505024
    s_cmp_lt_u32 s45, 196
    s_cselect_b32 s58, s58, 0x7f000000
    s_cselect_b32 s46, s46, 0x7f000000
    v_add_u32 v24, s41, v16
    v_mul_u32_u24 v25, 37, v24
    v_lshrrev_b32 v25, 8, v25
    v_mul_u32_u24 v26, 7, v25
    v_sub_u32 v24, v24, v26
    v_lshlrev_b32 v26, 2, v17
    v_mul_u32_u24 v27, 28, v17
    v_sub_u32 v28, 0, v26
    v_cmp_eq_u32 vcc, 3, v24
    s_nop 1
    v_cndmask_b32 v26, v26, v27, vcc
    v_cmp_lt_u32 vcc, 3, v24
    s_nop 1
    v_cndmask_b32 v26, v26, v28, vcc
    v_lshl_add_u32 v26, v24, 3, v26
    v_mad_u32_u24 v26, v25, 56, v26
    v_add_u32 v26, v26, v6
    v_mul_u32_u24 v26, 896, v26
    v_lshl_add_u32 v26, v4, 4, v26
    s_add_u32 m0, s101, 0
    s_nop 0
    buffer_load_dwordx4 v26, s[12:15], s58 offen lds
    v_add_u32 v24, s41, v16
    v_add_u32 v24, 2, v24
    v_mul_u32_u24 v25, 37, v24
    v_lshrrev_b32 v25, 8, v25
    v_mul_u32_u24 v26, 7, v25
    v_sub_u32 v24, v24, v26
    v_lshlrev_b32 v26, 2, v17
    v_mul_u32_u24 v27, 28, v17
    v_sub_u32 v28, 0, v26
    v_cmp_eq_u32 vcc, 3, v24
    s_nop 1
    v_cndmask_b32 v26, v26, v27, vcc
    v_cmp_lt_u32 vcc, 3, v24
    s_nop 1
    v_cndmask_b32 v26, v26, v28, vcc
    v_lshl_add_u32 v26, v24, 3, v26
    v_mad_u32_u24 v26, v25, 56, v26
    v_add_u32 v26, v26, v6
    v_mul_u32_u24 v26, 896, v26
    v_lshl_add_u32 v26, v4, 4, v26
    s_add_u32 m0, s101, 1024
    s_nop 0
    buffer_load_dwordx4 v26, s[12:15], s58 offen lds
    s_add_u32 s45, s45, 128
    s_mul_hi_u32 s58, s45, 0x12492493
    s_mul_i32 s41, s58, 14
    s_sub_u32 s41, s45, s41
    s_lshl_b32 s41, s41, 2
    s_lshl_b32 s58, s58, 6
    s_mul_i32 s47, s45, 2304
    s_add_u32 s47, s47, 5505024
    s_cmp_lt_u32 s45, 196
    s_cselect_b32 s58, s58, 0x7f000000
    s_cselect_b32 s47, s47, 0x7f000000
    v_add_u32 v24, s41, v16
    v_mul_u32_u24 v25, 37, v24
    v_lshrrev_b32 v25, 8, v25
    v_mul_u32_u24 v26, 7, v25
    v_sub_u32 v24, v24, v26
    v_lshlrev_b32 v26, 2, v17
    v_mul_u32_u24 v27, 28, v17
    v_sub_u32 v28, 0, v26
    v_cmp_eq_u32 vcc, 3, v24
    s_nop 1
    v_cndmask_b32 v26, v26, v27, vcc
    v_cmp_lt_u32 vcc, 3, v24
    s_nop 1
    v_cndmask_b32 v26, v26, v28, vcc
    v_lshl_add_u32 v26, v24, 3, v26
    v_mad_u32_u24 v26, v25, 56, v26
    v_add_u32 v26, v26, v6
    v_mul_u32_u24 v26, 896, v26
    v_lshl_add_u32 v26, v4, 4, v26
    s_add_u32 m0, s101, 2048
    s_nop 0
    buffer_load_dwordx4 v26, s[12:15], s58 offen lds
    v_add_u32 v24, s41, v16
    v_add_u32 v24, 2, v24
    v_mul_u32_u24 v25, 37, v24
    v_lshrrev_b32 v25, 8, v25
    v_mul_u32_u24 v26, 7, v25
    v_sub_u32 v24, v24, v26
    v_lshlrev_b32 v26, 2, v17
    v_mul_u32_u24 v27, 28, v17
    v_sub_u32 v28, 0, v26
    v_cmp_eq_u32 vcc, 3, v24
    s_nop 1
    v_cndmask_b32 v26, v26, v27, vcc
    v_cmp_lt_u32 vcc, 3, v24
    s_nop 1
    v_cndmask_b32 v26, v26, v28, vcc
    v_lshl_add_u32 v26, v24, 3, v26
    v_mad_u32_u24 v26, v25, 56, v26
    v_add_u32 v26, v26, v6
    v_mul_u32_u24 v26, 896, v26
    v_lshl_add_u32 v26, v4, 4, v26
    s_add_u32 m0, s101, 3072
    s_nop 0
    buffer_load_dwordx4 v26, s[12:15], s58 offen lds
    s_add_u32 s45, s45, 128
    s_waitcnt vmcnt(0)
    s_mov_b32 s91, 0
Ln_23:
    global_load_dword v24, v7, s[26:27] sc1
    s_waitcnt vmcnt(0)
Lnc_24:
    v_readfirstlane_b32 s33, v24
    s_add_u32 s91, s91, 1
    s_cmp_gt_u32 s91, 0x4000
    s_cbranch_scc1 Lnd_25
    s_cmp_eq_u32 s33, 0
    s_cbranch_scc1 Ln_23
Lnd_25:
    s_or_b32 s33, s33, 1
    ds_read_b64_tr_b16 v[32:33], v20 offset:0
    ds_read_b64_tr_b16 v[34:35], v20 offset:512
    ds_read_b64_tr_b16 v[36:37], v20 offset:1024
    ds_read_b64_tr_b16 v[38:39], v20 offset:1536
    ds_read_b64_tr_b16 v[40:41], v20 offset:2048
    ds_read_b64_tr_b16 v[42:43], v20 offset:2560
    ds_read_b64_tr_b16 v[44:45], v20 offset:3072
    ds_read_b64_tr_b16 v[46:47], v20 offset:3584
    s_waitcnt lgkmcnt(0)
    buffer_store_dwordx4 v[32:35], v2, s[20:23], s46 offen sc1
    buffer_store_dwordx4 v[36:39], v2, s[20:23], s46 offen offset:1024 sc1
    v_bitop3_b32 v50, v32, v33, s33 bitop3:0x96
    v_bitop3_b32 v50, v50, v34, v35 bitop3:0x96
    v_bitop3_b32 v50, v50, v36, v37 bitop3:0x96
    v_bitop3_b32 v50, v50, v38, v39 bitop3:0x96
    buffer_store_dword v50, v3, s[20:23], s46 offen offset:2048 sc1
    buffer_store_dwordx4 v[40:43], v2, s[20:23], s47 offen sc1
    buffer_store_dwordx4 v[44:47], v2, s[20:23], s47 offen offset:1024 sc1
    v_bitop3_b32 v51, v40, v41, s33 bitop3:0x96
    v_bitop3_b32 v51, v51, v42, v43 bitop3:0x96
    v_bitop3_b32 v51, v51, v44, v45 bitop3:0x96
    v_bitop3_b32 v51, v51, v46, v47 bitop3:0x96
    buffer_store_dword v51, v3, s[20:23], s47 offen offset:2048 sc1
    s_cmp_ge_u32 s30, 4
    s_cbranch_scc0 L_end
    s_waitcnt vmcnt(0)
    s_barrier
    s_and_b32 s90, s3, 15
    s_lshl_b32 s90, s90, 2
    s_and_b32 s91, s30, 3
    s_add_u32 s90, s90, s91
    v_lshlrev_b32 v12, 7, v1
    s_lshl_b32 s91, s31, 6
    s_add_u32 s91, s91, s90
    s_lshl_b32 s92, s91, 12
    s_add_u32 s92, s92, 1048576
    s_mov_b32 exec_hi, 0
    buffer_load_dword v254, v12, s[20:23], s92 offen sc1
    s_lshl_b32 s92, s91, 9
    s_add_u32 s92, s92, 524288
    s_mov_b32 exec_lo, 15
    buffer_load_dword v254, v12, s[20:23], s92 offen sc1
    s_mul_i32 s90, s90, 7168
    s_add_u32 s90, s90, 5505024
    s_mov_b32 exec_lo, -1
    s_mov_b32 exec_hi, 0xffffff
    buffer_load_dword v254, v12, s[20:23], s90 offen sc1
    s_mov_b64 exec, -1
    s_endpgm
L_end:
    s_endpgm
L_code_end:
.p2align 8
.type gather_tab,@object
gather_tab:
.long 0x01280128, 0x01280128, 0x07ee07ee, 0x07ee07ee, 0x07ee07ee, 0x07b607ee, 0x07b607b6, 0x07b607b6
.long 0x07b607b6, 0x07b607b6, 0x077e077e, 0x077e077e, 0x077e077e, 0x0746077e, 0x07460746, 0x07460746
.long 0x07460746, 0x07460746, 0x070e070e, 0x070e070e, 0x070e070e, 0x06d6070e, 0x06d606d6, 0x06d606d6
.long 0x06d606d6, 0x06d606d6, 0x069e069e, 0x069e069e, 0x069e069e, 0x0666069e, 0x06660666, 0x06660666
.long 0x06660666, 0x06660666, 0x062e062e, 0x062e062e, 0x062e062e, 0x05f6062e, 0x05f605f6, 0x05f605f6
.long 0x05f605f6, 0x05f605f6, 0x05be05be, 0x05be05be, 0x05be05be, 0x058605be, 0x05860586, 0x05860586
.long 0x05860586, 0x05860586, 0x054e054e, 0x054e054e, 0x054e054e, 0x0516054e, 0x05160516, 0x05160516
.long 0x05160516, 0x05160516, 0x04de04de, 0x04de04de, 0x04de04de, 0x04a604de, 0x04a604a6, 0x04a604a6
.long 0x04a604a6, 0x04a604a6, 0x046e046e, 0x046e046e, 0x046e046e, 0x0436046e, 0x04360436, 0x04360436
.long 0x04360436, 0x04360436, 0x03fe03fe, 0x03fe03fe, 0x03fe03fe, 0x03c603fe, 0x03c603c6, 0x03c603c6
.long 0x03c603c6, 0x03c603c6, 0x038e038e, 0x038e038e, 0x038e038e, 0x0356038e, 0x03560356, 0x03560356
.long 0x03560356, 0x03560356, 0x031e031e, 0x031e031e, 0x031e031e, 0x02e6031e, 0x02e602e6, 0x02e602e6
.long 0x02e602e6, 0x02e602e6, 0x02ae02ae, 0x02ae02ae, 0x02ae02ae, 0x027602ae, 0x02760276, 0x02760276
.long 0x02760276, 0x02760276, 0x023e023e, 0x023e023e, 0x023e023e, 0x0206023e, 0x02060206, 0x02060206
.long 0x02060206, 0x02060206, 0x01ce01ce, 0x01ce01ce, 0x01ce01ce, 0x019601ce, 0x01960196, 0x01960196
.long 0x01960196, 0x01960196, 0x015e015e, 0x015e015e, 0x015e015e, 0x0126015e, 0x01260126, 0x01260126
.long 0x01260126, 0x01260126, 0x07ec07ec, 0x07ec07ec, 0x07ec07ec, 0x07b407ec, 0x07b407b4, 0x07b407b4
.long 0x07b407b4, 0x07b407b4, 0x077c077c, 0x077c077c, 0x077c077c, 0x0744077c, 0x07440744, 0x07440744
.long 0x07440744, 0x07440744, 0x070c070c, 0x070c070c, 0x070c070c, 0x06d4070c, 0x06d406d4, 0x06d406d4
.long 0x06d406d4, 0x06d406d4, 0x069c069c, 0x069c069c, 0x069c069c, 0x0664069c, 0x06640664, 0x06640664
.long 0x06640664, 0x06640664, 0x062c062c, 0x062c062c, 0x062c062c, 0x05f4062c, 0x05f405f4, 0x05f405f4
.long 0x05f405f4, 0x05f405f4, 0x05bc05bc, 0x05bc05bc, 0x05bc05bc, 0x058405bc, 0x05840584, 0x05840584
.long 0x05840584, 0x05840584, 0x054c054c, 0x054c054c, 0x054c054c, 0x0514054c, 0x05140514, 0x05140514
.long 0x05140514, 0x05140514, 0x04dc04dc, 0x04dc04dc, 0x04dc04dc, 0x04a404dc, 0x04a404a4, 0x04a404a4
.long 0x04a404a4, 0x04a404a4, 0x046c046c, 0x046c046c, 0x046c046c, 0x0434046c, 0x04340434, 0x04340434
.long 0x04340434, 0x04340434, 0x03fc03fc, 0x03fc03fc, 0x03fc03fc, 0x03c403fc, 0x03c403c4, 0x03c403c4
.long 0x03c403c4, 0x03c403c4, 0x038c038c, 0x038c038c, 0x038c038c, 0x0354038c, 0x03540354, 0x03540354
.long 0x03540354, 0x03540354, 0x031c031c, 0x031c031c, 0x031c031c, 0x02e4031c, 0x02e402e4, 0x02e402e4
.long 0x02e402e4, 0x02e402e4, 0x02ac02ac, 0x02ac02ac, 0x02ac02ac, 0x027402ac, 0x02740274, 0x02740274
.long 0x02740274, 0x02740274, 0x023c023c, 0x023c023c, 0x023c023c, 0x0204023c, 0x02040204, 0x02040204
.long 0x02040204, 0x02040204, 0x01cc01cc, 0x01cc01cc, 0x01cc01cc, 0x019401cc, 0x01940194, 0x01940194
.long 0x01940194, 0x01940194, 0x015c015c, 0x015c015c, 0x015c015c, 0x0124015c, 0x01240124, 0x01240124
.long 0x07ee07ee, 0x07b607ee, 0x01240124, 0x01240124, 0x07b607b6, 0x07b607b6, 0x07ea07ea, 0x07b207ea
.long 0x077e077e, 0x0746077e, 0x07b207b2, 0x07b207b2, 0x07460746, 0x07460746, 0x077a077a, 0x0742077a
.long 0x070e070e, 0x06d6070e, 0x07420742, 0x07420742, 0x06d606d6, 0x06d606d6, 0x070a070a, 0x06d2070a
.long 0x069e069e, 0x0666069e, 0x06d206d2, 0x06d206d2, 0x06660666, 0x06660666, 0x069a069a, 0x0662069a
.long 0x062e062e, 0x05f6062e, 0x06620662, 0x06620662, 0x05f605f6, 0x05f605f6, 0x062a062a, 0x05f2062a
.long 0x05be05be, 0x058605be, 0x05f205f2, 0x05f205f2, 0x05860586, 0x05860586, 0x05ba05ba, 0x058205ba
.long 0x054e054e, 0x0516054e, 0x05820582, 0x05820582, 0x05160516, 0x05160516, 0x054a054a, 0x0512054a
.long 0x04de04de, 0x04a604de, 0x05120512, 0x05120512, 0x04a604a6, 0x04a604a6, 0x04da04da, 0x04a204da
.long 0x046e046e, 0x0436046e, 0x04a204a2, 0x04a204a2, 0x04360436, 0x04360436, 0x046a046a, 0x0432046a
.long 0x03fe03fe, 0x03c603fe, 0x04320432, 0x04320432, 0x03c603c6, 0x03c603c6, 0x03fa03fa, 0x03c203fa
.long 0x038e038e, 0x0356038e, 0x03c203c2, 0x03c203c2, 0x03560356, 0x03560356, 0x038a038a, 0x0352038a
.long 0x031e031e, 0x02e6031e, 0x03520352, 0x03520352, 0x02e602e6, 0x02e602e6, 0x031a031a, 0x02e2031a
.long 0x02ae02ae, 0x027602ae, 0x02e202e2, 0x02e202e2, 0x02760276, 0x02760276, 0x02aa02aa, 0x027202aa
.long 0x023e023e, 0x0206023e, 0x02720272, 0x02720272, 0x02060206, 0x02060206, 0x023a023a, 0x0202023a
.long 0x01ce01ce, 0x019601ce, 0x02020202, 0x02020202, 0x01960196, 0x01960196, 0x01ca01ca, 0x019201ca
.long 0x015e015e, 0x0126015e, 0x01920192, 0x01920192, 0x01260126, 0x01260126, 0x015a015a, 0x0122015a
.long 0x07ec07ec, 0x07b407ec, 0x01220122, 0x01220122, 0x07b407b4, 0x07b407b4, 0x07e807e8, 0x07b007e8
.long 0x077c077c, 0x0744077c, 0x07b007b0, 0x07b007b0, 0x07440744, 0x07440744, 0x07780778, 0x07400778
.long 0x070c070c, 0x06d4070c, 0x07400740, 0x07400740, 0x06d406d4, 0x06d406d4, 0x07080708, 0x06d00708
.long 0x069c069c, 0x0664069c, 0x06d006d0, 0x06d006d0, 0x06640664, 0x06640664, 0x06980698, 0x06600698
.long 0x062c062c, 0x05f4062c, 0x06600660, 0x06600660, 0x05f405f4, 0x05f405f4, 0x06280628, 0x05f00628
.long 0x05bc05bc, 0x058405bc, 0x05f005f0, 0x05f005f0, 0x05840584, 0x05840584, 0x05b805b8, 0x058005b8
.long 0x054c054c, 0x0514054c, 0x05800580, 0x05800580, 0x05140514, 0x05140514, 0x05480548, 0x05100548
.long 0x04dc04dc, 0x04a404dc, 0x05100510, 0x05100510, 0x04a404a4, 0x04a404a4, 0x04d804d8, 0x04a004d8
.long 0x046c046c, 0x0434046c, 0x04a004a0, 0x04a004a0, 0x04340434, 0x04340434, 0x04680468, 0x04300468
.long 0x03fc03fc, 0x03c403fc, 0x04300430, 0x04300430, 0x03c403c4, 0x03c403c4, 0x03f803f8, 0x03c003f8
.long 0x038c038c, 0x0354038c, 0x03c003c0, 0x03c003c0, 0x03540354, 0x03540354, 0x03880388, 0x03500388
.long 0x031c031c, 0x02e4031c, 0x03500350, 0x03500350, 0x02e402e4, 0x02e402e4, 0x03180318, 0x02e00318
.long 0x02ac02ac, 0x027402ac, 0x02e002e0, 0x02e002e0, 0x02740274, 0x02740274, 0x02a802a8, 0x027002a8
.long 0x023c023c, 0x0204023c, 0x02700270, 0x02700270, 0x02040204, 0x02040204, 0x02380238, 0x02000238
.long 0x01cc01cc, 0x019401cc, 0x02000200, 0x02000200, 0x01940194, 0x01940194, 0x01c801c8, 0x019001c8
.long 0x015c015c, 0x0124015c, 0x01900190, 0x01900190, 0x01240124, 0x01240124, 0x01580158, 0x01200158
.long 0x07ea07ea, 0x07ea07ea, 0x07ea07ea, 0x07b207ea, 0x07b207b2, 0x07b207b2, 0x07b207b2, 0x07b207b2
.long 0x077a077a, 0x077a077a, 0x077a077a, 0x0742077a, 0x07420742, 0x07420742, 0x07420742, 0x07420742
.long 0x070a070a, 0x070a070a, 0x070a070a, 0x06d2070a, 0x06d206d2, 0x06d206d2, 0x06d206d2, 0x06d206d2
.long 0x069a069a, 0x069a069a, 0x069a069a, 0x0662069a, 0x06620662, 0x06620662, 0x06620662, 0x06620662
.long 0x062a062a, 0x062a062a, 0x062a062a, 0x05f2062a, 0x05f205f2, 0x05f205f2, 0x05f205f2, 0x05f205f2
.long 0x05ba05ba, 0x05ba05ba, 0x05ba05ba, 0x058205ba, 0x05820582, 0x05820582, 0x05820582, 0x05820582
.long 0x054a054a, 0x054a054a, 0x054a054a, 0x0512054a, 0x05120512, 0x05120512, 0x05120512, 0x05120512
.long 0x04da04da, 0x04da04da, 0x04da04da, 0x04a204da, 0x04a204a2, 0x04a204a2, 0x04a204a2, 0x04a204a2
.long 0x046a046a, 0x046a046a, 0x046a046a, 0x0432046a, 0x04320432, 0x04320432, 0x04320432, 0x04320432
.long 0x03fa03fa, 0x03fa03fa, 0x03fa03fa, 0x03c203fa, 0x03c203c2, 0x03c203c2, 0x03c203c2, 0x03c203c2
.long 0x038a038a, 0x038a038a, 0x038a038a, 0x0352038a, 0x03520352, 0x03520352, 0x03520352, 0x03520352
.long 0x031a031a, 0x031a031a, 0x031a031a, 0x02e2031a, 0x02e202e2, 0x02e202e2, 0x02e202e2, 0x02e202e2
.long 0x02aa02aa, 0x02aa02aa, 0x02aa02aa, 0x027202aa, 0x02720272, 0x02720272, 0x02720272, 0x02720272
.long 0x023a023a, 0x023a023a, 0x023a023a, 0x0202023a, 0x02020202, 0x02020202, 0x02020202, 0x02020202
.long 0x01ca01ca, 0x01ca01ca, 0x01ca01ca, 0x019201ca, 0x01920192, 0x01920192, 0x01920192, 0x01920192
.long 0x015a015a, 0x015a015a, 0x015a015a, 0x0122015a, 0x01220122, 0x01220122, 0x01220122, 0x01220122
.long 0x07e807e8, 0x07e807e8, 0x07e807e8, 0x07b007e8, 0x07b007b0, 0x07b007b0, 0x07b007b0, 0x07b007b0
.long 0x07780778, 0x07780778, 0x07780778, 0x07400778, 0x07400740, 0x07400740, 0x07400740, 0x07400740
.long 0x07080708, 0x07080708, 0x07080708, 0x06d00708, 0x06d006d0, 0x06d006d0, 0x06d006d0, 0x06d006d0
.long 0x06980698, 0x06980698, 0x06980698, 0x06600698, 0x06600660, 0x06600660, 0x06600660, 0x06600660
.long 0x06280628, 0x06280628, 0x06280628, 0x05f00628, 0x05f005f0, 0x05f005f0, 0x05f005f0, 0x05f005f0
.long 0x05b805b8, 0x05b805b8, 0x05b805b8, 0x058005b8, 0x05800580, 0x05800580, 0x05800580, 0x05800580
.long 0x05480548, 0x05480548, 0x05480548, 0x05100548, 0x05100510, 0x05100510, 0x05100510, 0x05100510
.long 0x04d804d8, 0x04d804d8, 0x04d804d8, 0x04a004d8, 0x04a004a0, 0x04a004a0, 0x04a004a0, 0x04a004a0
.long 0x04680468, 0x04680468, 0x04680468, 0x04300468, 0x04300430, 0x04300430, 0x04300430, 0x04300430
.long 0x03f803f8, 0x03f803f8, 0x03f803f8, 0x03c003f8, 0x03c003c0, 0x03c003c0, 0x03c003c0, 0x03c003c0
.long 0x03880388, 0x03880388, 0x03880388, 0x03500388, 0x03500350, 0x03500350, 0x03500350, 0x03500350
.long 0x03180318, 0x03180318, 0x03180318, 0x02e00318, 0x02e002e0, 0x02e002e0, 0x02e002e0, 0x02e002e0
.long 0x02a802a8, 0x02a802a8, 0x02a802a8, 0x027002a8, 0x02700270, 0x02700270, 0x02700270, 0x02700270
.long 0x02380238, 0x02380238, 0x02380238, 0x02000238, 0x02000200, 0x02000200, 0x02000200, 0x02000200
.long 0x01c801c8, 0x01c801c8, 0x01c801c8, 0x019001c8, 0x01900190, 0x01900190, 0x01900190, 0x01900190
.long 0x01580158, 0x01580158, 0x01580158, 0x01200158, 0x01200120, 0x01200120, 0x01200120, 0x07e607e6
.long 0x01200120, 0x07e607e6, 0x07e407e6, 0x07e407e4, 0x07e407e4, 0x07ae07ae, 0x07ac07ae, 0x07ac07ac
.long 0x07ac07ac, 0x07760776, 0x07740776, 0x07740774, 0x07740774, 0x073e073e, 0x073c073e, 0x073c073c
.long 0x073c073c, 0x07060706, 0x07040706, 0x07040704, 0x07040704, 0x06ce06ce, 0x06cc06ce, 0x06cc06cc
.long 0x06cc06cc, 0x06960696, 0x06940696, 0x06940694, 0x06940694, 0x065e065e, 0x065c065e, 0x065c065c
.long 0x065c065c, 0x06260626, 0x06240626, 0x06240624, 0x06240624, 0x05ee05ee, 0x05ec05ee, 0x05ec05ec
.long 0x05ec05ec, 0x05b605b6, 0x05b405b6, 0x05b405b4, 0x05b405b4, 0x057e057e, 0x057c057e, 0x057c057c
.long 0x057c057c, 0x05460546, 0x05440546, 0x05440544, 0x05440544, 0x050e050e, 0x050c050e, 0x050c050c
.long 0x050c050c, 0x04d604d6, 0x04d404d6, 0x04d404d4, 0x04d404d4, 0x049e049e, 0x049c049e, 0x049c049c
.long 0x049c049c, 0x04660466, 0x04640466, 0x04640464, 0x04640464, 0x042e042e, 0x042c042e, 0x042c042c
.long 0x042c042c, 0x03f603f6, 0x03f403f6, 0x03f403f4, 0x03f403f4, 0x03be03be, 0x03bc03be, 0x03bc03bc
.long 0x03bc03bc, 0x03860386, 0x03840386, 0x03840384, 0x03840384, 0x034e034e, 0x034c034e, 0x034c034c
.long 0x034c034c, 0x03160316, 0x03140316, 0x03140314, 0x03140314, 0x02de02de, 0x02dc02de, 0x02dc02dc
.long 0x02dc02dc, 0x02a602a6, 0x02a402a6, 0x02a402a4, 0x02a402a4, 0x026e026e, 0x026c026e, 0x026c026c
.long 0x026c026c, 0x02360236, 0x02340236, 0x02340234, 0x02340234, 0x01fe01fe, 0x01fc01fe, 0x01fc01fc
.long 0x01fc01fc, 0x01c601c6, 0x01c401c6, 0x01c401c4, 0x01c401c4, 0x018e018e, 0x018c018e, 0x018c018c
.long 0x018c018c, 0x01560156, 0x01540156, 0x01540154, 0x01540154, 0x011e011e, 0x011c011e, 0x011c011c
.long 0x011c011c, 0x07e207e2, 0x07e007e2, 0x07e007e0, 0x07e007e0, 0x07aa07aa, 0x07a807aa, 0x07a807a8
.long 0x07a807a8, 0x07720772, 0x07700772, 0x07700770, 0x07700770, 0x073a073a, 0x0738073a, 0x07380738
.long 0x07380738, 0x07020702, 0x07000702, 0x07000700, 0x07000700, 0x06ca06ca, 0x06c806ca, 0x06c806c8
.long 0x06c806c8, 0x06920692, 0x06900692, 0x06900690, 0x06900690, 0x065a065a, 0x0658065a, 0x06580658
.long 0x06580658, 0x06220622, 0x06200622, 0x06200620, 0x06200620, 0x05ea05ea, 0x05e805ea, 0x05e805e8
.long 0x05e805e8, 0x05b205b2, 0x05b005b2, 0x05b005b0, 0x05b005b0, 0x057a057a, 0x0578057a, 0x05780578
.long 0x05780578, 0x05420542, 0x05400542, 0x05400540, 0x05400540, 0x050a050a, 0x0508050a, 0x05080508
.long 0x05080508, 0x04d204d2, 0x04d004d2, 0x04d004d0, 0x04d004d0, 0x049a049a, 0x0498049a, 0x04980498
.long 0x04980498, 0x04620462, 0x04600462, 0x04600460, 0x04600460, 0x042a042a, 0x0428042a, 0x04280428
.long 0x04280428, 0x03f203f2, 0x03f003f2, 0x03f003f0, 0x03f003f0, 0x03ba03ba, 0x03b803ba, 0x03b803b8
.long 0x03b803b8, 0x03820382, 0x03800382, 0x03800380, 0x03800380, 0x034a034a, 0x0348034a, 0x03480348
.long 0x03480348, 0x03120312, 0x03100312, 0x03100310, 0x03100310, 0x02da02da, 0x02d802da, 0x02d802d8
.long 0x02d802d8, 0x02a202a2, 0x02a002a2, 0x02a002a0, 0x02a002a0, 0x026a026a, 0x0268026a, 0x02680268
.long 0x02680268, 0x02320232, 0x02300232, 0x02300230, 0x02300230, 0x01fa01fa, 0x01f801fa, 0x01f801f8
.long 0x01f801f8, 0x01c201c2, 0x01c001c2, 0x01c001c0, 0x01c001c0, 0x018a018a, 0x0188018a, 0x01880188
.long 0x01880188, 0x01520152, 0x01500152, 0x01500150, 0x01500150, 0x011a011a, 0x0118011a, 0x01180118
.long 0x07e407e4, 0x07ae07ae, 0x07de0118, 0x07dc07dc, 0x07ac07ac, 0x07760776, 0x07a607d8, 0x07a407a4
.long 0x07740774, 0x073e073e, 0x076e07a0, 0x076c076c, 0x073c073c, 0x07060706, 0x07360768, 0x07340734
.long 0x07040704, 0x06ce06ce, 0x06fe0730, 0x06fc06fc, 0x06cc06cc, 0x06960696, 0x06c606f8, 0x06c406c4
.long 0x06940694, 0x065e065e, 0x068e06c0, 0x068c068c, 0x065c065c, 0x06260626, 0x06560688, 0x06540654
.long 0x06240624, 0x05ee05ee, 0x061e0650, 0x061c061c, 0x05ec05ec, 0x05b605b6, 0x05e60618, 0x05e405e4
.long 0x05b405b4, 0x057e057e, 0x05ae05e0, 0x05ac05ac, 0x057c057c, 0x05460546, 0x057605a8, 0x05740574
.long 0x05440544, 0x050e050e, 0x053e0570, 0x053c053c, 0x050c050c, 0x04d604d6, 0x05060538, 0x05040504
.long 0x04d404d4, 0x049e049e, 0x04ce0500, 0x04cc04cc, 0x049c049c, 0x04660466, 0x049604c8, 0x04940494
.long 0x04640464, 0x042e042e, 0x045e0490, 0x045c045c, 0x042c042c, 0x03f603f6, 0x04260458, 0x04240424
.long 0x03f403f4, 0x03be03be, 0x03ee0420, 0x03ec03ec, 0x03bc03bc, 0x03860386, 0x03b603e8, 0x03b403b4
.long 0x03840384, 0x034e034e, 0x037e03b0, 0x037c037c, 0x034c034c, 0x03160316, 0x03460378, 0x03440344
.long 0x03140314, 0x02de02de, 0x030e0340, 0x030c030c, 0x02dc02dc, 0x02a602a6, 0x02d60308, 0x02d402d4
.long 0x02a402a4, 0x026e026e, 0x029e02d0, 0x029c029c, 0x026c026c, 0x02360236, 0x02660298, 0x02640264
.long 0x02340234, 0x01fe01fe, 0x022e0260, 0x022c022c, 0x01fc01fc, 0x01c601c6, 0x01f60228, 0x01f401f4
.long 0x01c401c4, 0x018e018e, 0x01be01f0, 0x01bc01bc, 0x018c018c, 0x01560156, 0x018601b8, 0x01840184
.long 0x01540154, 0x011e011e, 0x014e0180, 0x014c014c, 0x011c011c, 0x07e207e2, 0x01160148, 0x01140114
.long 0x07e007e0, 0x07aa07aa, 0x07d407d6, 0x07d007d2, 0x07a807a8, 0x07720772, 0x079c079e, 0x0798079a
.long 0x07700770, 0x073a073a, 0x07640766, 0x07600762, 0x07380738, 0x07020702, 0x072c072e, 0x0728072a
.long 0x07000700, 0x06ca06ca, 0x06f406f6, 0x06f006f2, 0x06c806c8, 0x06920692, 0x06bc06be, 0x06b806ba
.long 0x06900690, 0x065a065a, 0x06840686, 0x06800682, 0x06580658, 0x06220622, 0x064c064e, 0x0648064a
.long 0x06200620, 0x05ea05ea, 0x06140616, 0x06100612, 0x05e805e8, 0x05b205b2, 0x05dc05de, 0x05d805da
.long 0x05b005b0, 0x057a057a, 0x05a405a6, 0x05a005a2, 0x05780578, 0x05420542, 0x056c056e, 0x0568056a
.long 0x05400540, 0x050a050a, 0x05340536, 0x05300532, 0x05080508, 0x04d204d2, 0x04fc04fe, 0x04f804fa
.long 0x04d004d0, 0x049a049a, 0x04c404c6, 0x04c004c2, 0x04980498, 0x04620462, 0x048c048e, 0x0488048a
.long 0x04600460, 0x042a042a, 0x04540456, 0x04500452, 0x04280428, 0x03f203f2, 0x041c041e, 0x0418041a
.long 0x03f003f0, 0x03ba03ba, 0x03e403e6, 0x03e003e2, 0x03b803b8, 0x03820382, 0x03ac03ae, 0x03a803aa
.long 0x03800380, 0x034a034a, 0x03740376, 0x03700372, 0x03480348, 0x03120312, 0x033c033e, 0x0338033a
.long 0x03100310, 0x02da02da, 0x03040306, 0x03000302, 0x02d802d8, 0x02a202a2, 0x02cc02ce, 0x02c802ca
.long 0x02a002a0, 0x026a026a, 0x02940296, 0x02900292, 0x02680268, 0x02320232, 0x025c025e, 0x0258025a
.long 0x02300230, 0x01fa01fa, 0x02240226, 0x02200222, 0x01f801f8, 0x01c201c2, 0x01ec01ee, 0x01e801ea
.long 0x01c001c0, 0x018a018a, 0x01b401b6, 0x01b001b2, 0x01880188, 0x01520152, 0x017c017e, 0x0178017a
.long 0x01500150, 0x011a011a, 0x01440146, 0x01400142, 0x07de0118, 0x07dc07dc, 0x010c010e, 0x0108010a
.long 0x07da07dc, 0x07d807d8, 0x07a607d8, 0x07a407a4, 0x07a207a4, 0x07a007a0, 0x076e07a0, 0x076c076c
.long 0x076a076c, 0x07680768, 0x07360768, 0x07340734, 0x07320734, 0x07300730, 0x06fe0730, 0x06fc06fc
.long 0x06fa06fc, 0x06f806f8, 0x06c606f8, 0x06c406c4, 0x06c206c4, 0x06c006c0, 0x068e06c0, 0x068c068c
.long 0x068a068c, 0x06880688, 0x06560688, 0x06540654, 0x06520654, 0x06500650, 0x061e0650, 0x061c061c
.long 0x061a061c, 0x06180618, 0x05e60618, 0x05e405e4, 0x05e205e4, 0x05e005e0, 0x05ae05e0, 0x05ac05ac
.long 0x05aa05ac, 0x05a805a8, 0x057605a8, 0x05740574, 0x05720574, 0x05700570, 0x053e0570, 0x053c053c
.long 0x053a053c, 0x05380538, 0x05060538, 0x05040504, 0x05020504, 0x05000500, 0x04ce0500, 0x04cc04cc
.long 0x04ca04cc, 0x04c804c8, 0x049604c8, 0x04940494, 0x04920494, 0x04900490, 0x045e0490, 0x045c045c
.long 0x045a045c, 0x04580458, 0x04260458, 0x04240424, 0x04220424, 0x04200420, 0x03ee0420, 0x03ec03ec
.long 0x03ea03ec, 0x03e803e8, 0x03b603e8, 0x03b403b4, 0x03b203b4, 0x03b003b0, 0x037e03b0, 0x037c037c
.long 0x037a037c, 0x03780378, 0x03460378, 0x03440344, 0x03420344, 0x03400340, 0x030e0340, 0x030c030c
.long 0x030a030c, 0x03080308, 0x02d60308, 0x02d402d4, 0x02d202d4, 0x02d002d0, 0x029e02d0, 0x029c029c
.long 0x029a029c, 0x02980298, 0x02660298, 0x02640264, 0x02620264, 0x02600260, 0x022e0260, 0x022c022c
.long 0x022a022c, 0x02280228, 0x01f60228, 0x01f401f4, 0x01f201f4, 0x01f001f0, 0x01be01f0, 0x01bc01bc
.long 0x01ba01bc, 0x01b801b8, 0x018601b8, 0x01840184, 0x01820184, 0x01800180, 0x014e0180, 0x014c014c
.long 0x014a014c, 0x01480148, 0x01160148, 0x01140114, 0x01120114, 0x01100110, 0x07d407d6, 0x07d007d2
.long 0x07cc07ce, 0x07c807ca, 0x079c079e, 0x0798079a, 0x07940796, 0x07900792, 0x07640766, 0x07600762
.long 0x075c075e, 0x0758075a, 0x072c072e, 0x0728072a, 0x07240726, 0x07200722, 0x06f406f6, 0x06f006f2
.long 0x06ec06ee, 0x06e806ea, 0x06bc06be, 0x06b806ba, 0x06b406b6, 0x06b006b2, 0x06840686, 0x06800682
.long 0x067c067e, 0x0678067a, 0x064c064e, 0x0648064a, 0x06440646, 0x06400642, 0x06140616, 0x06100612
.long 0x060c060e, 0x0608060a, 0x05dc05de, 0x05d805da, 0x05d405d6, 0x05d005d2, 0x05a405a6, 0x05a005a2
.long 0x059c059e, 0x0598059a, 0x056c056e, 0x0568056a, 0x05640566, 0x05600562, 0x05340536, 0x05300532
.long 0x052c052e, 0x0528052a, 0x04fc04fe, 0x04f804fa, 0x04f404f6, 0x04f004f2, 0x04c404c6, 0x04c004c2
.long 0x04bc04be, 0x04b804ba, 0x048c048e, 0x0488048a, 0x04840486, 0x04800482, 0x04540456, 0x04500452
.long 0x044c044e, 0x0448044a, 0x041c041e, 0x0418041a, 0x04140416, 0x04100412, 0x03e403e6, 0x03e003e2
.long 0x03dc03de, 0x03d803da, 0x03ac03ae, 0x03a803aa, 0x03a403a6, 0x03a003a2, 0x03740376, 0x03700372
.long 0x036c036e, 0x0368036a, 0x033c033e, 0x0338033a, 0x03340336, 0x03300332, 0x03040306, 0x03000302
.long 0x02fc02fe, 0x02f802fa, 0x02cc02ce, 0x02c802ca, 0x02c402c6, 0x02c002c2, 0x02940296, 0x02900292
.long 0x028c028e, 0x0288028a, 0x025c025e, 0x0258025a, 0x02540256, 0x02500252, 0x02240226, 0x02200222
.long 0x021c021e, 0x0218021a, 0x01ec01ee, 0x01e801ea, 0x01e401e6, 0x01e001e2, 0x01b401b6, 0x01b001b2
.long 0x01ac01ae, 0x01a801aa, 0x017c017e, 0x0178017a, 0x01740176, 0x01700172, 0x01440146, 0x01400142
.long 0x013c013e, 0x0138013a, 0x010c010e, 0x0108010a, 0x01040106, 0x01000102, 0x012e012e, 0x012e012e
.long 0x00000000, 0x00000000, 0x00000000, 0x00000000, 0x00000000, 0x00000000, 0x00000000, 0x00000000
.long 0x00000000, 0x00000000, 0x00000000, 0x00000000, 0x00000000, 0x00000000, 0x00000000, 0x00000000
.long 0x00000000, 0x00000000, 0x00000000, 0x00000000, 0x00000000, 0x00000000, 0x00000000, 0x00000000
.long 0x00000000, 0x00000000, 0x00000000, 0x00000000, 0x00000000, 0x00000000, 0x00000000, 0x00000000
.long 0x00000000, 0x00000000, 0x00000000, 0x00000000, 0x00000000, 0x00000000, 0x00000000, 0x00000000
.long 0x00000000, 0x00000000, 0x00000000, 0x00000000, 0x00000000, 0x00000000, 0x00000000, 0x00000000
.long 0x00000000, 0x00000000, 0x00000000, 0x00000000, 0x00000000, 0x00000000, 0x00000000, 0x00000000
.long 0x00000000, 0x00000000, 0x00000000, 0x00000000, 0x00000000, 0x00000000, 0x00000000, 0x00000000
.long 0x00000000, 0x00000000, 0x00000000, 0x00000000, 0x00000000, 0x00000000, 0x00000000, 0x00000000
.long 0x00000000, 0x00000000, 0x00000000, 0x00000000, 0x00000000, 0x00000000, 0x00000000, 0x00000000
.long 0x00000000, 0x00000000, 0x00000000, 0x00000000, 0x00000000, 0x00000000, 0x00000000, 0x00000000
.long 0x00000000, 0x00000000, 0x00000000, 0x00000000, 0x00000000, 0x00000000, 0x00000000, 0x00000000
.long 0x00000000, 0x00000000, 0x00000000, 0x00000000, 0x00000000, 0x00000000, 0x00000000, 0x00000000
.long 0x00000000, 0x00000000, 0x00000000, 0x00000000, 0x00000000, 0x00000000, 0x00000000, 0x00000000
.long 0x00000000, 0x00000000, 0x00000000, 0x00000000, 0x00000000, 0x00000000, 0x00000000, 0x00000000
.long 0x00000000, 0x00000000, 0x00000000, 0x00000000, 0x00000000, 0x00000000, 0x00000000, 0x00000000
.long 0x00000000, 0x00000000, 0x00000000, 0x00000000, 0x00000000, 0x00000000, 0x00000000, 0x00000000
.long 0x00000000, 0x00000000, 0x00000000, 0x00000000, 0x00000000, 0x00000000, 0x00000000, 0x00000000
.long 0x00000000, 0x00000000, 0x00000000, 0x00000000, 0x00000000, 0x00000000, 0x00000000, 0x00000000
.long 0x00000000, 0x00000000, 0x00000000, 0x00000000, 0x00000000, 0x00000000, 0x00000000, 0x00000000
.long 0x00000000, 0x00000000, 0x00000000, 0x00000000, 0x00000000, 0x00000000, 0x00000000, 0x00000000
.long 0x00000000, 0x00000000, 0x00000000, 0x00000000, 0x00000000, 0x00000000, 0x00000000, 0x00000000
.long 0x00000000, 0x00000000, 0x00000000, 0x00000000, 0x00000000, 0x00000000, 0x00000000, 0x00000000
.long 0x00000000, 0x00000000, 0x00000000, 0x00000000, 0x00000000, 0x00000000, 0x00000000, 0x00000000
.long 0x00000000, 0x00000000, 0x00000000, 0x00000000, 0x00000000, 0x00000000, 0x00000000, 0x00000000
.long 0x00000000, 0x00000000, 0x00000000, 0x00000000, 0x00000000, 0x00000000, 0x00000000, 0x00000000
.long 0x00000000, 0x00000000, 0x00000000, 0x00000000, 0x00000000, 0x00000000, 0x00000000, 0x00000000
.long 0x00000000, 0x00000000, 0x00000000, 0x00000000, 0x00000000, 0x00000000, 0x00000000, 0x00000000
.long 0x00000000, 0x00000000, 0x00000000, 0x00000000, 0x00000000, 0x00000000, 0x00000000, 0x00000000
.long 0x00000000, 0x00000000, 0x00000000, 0x00000000, 0x00000000, 0x00000000, 0x00000000, 0x00000000
.long 0x00000000, 0x00000000, 0x00000000, 0x00000000, 0x00000000, 0x00000000, 0x00000000, 0x00000000
.long 0x00000000, 0x00000000, 0x00000000, 0x00000000, 0x00000000, 0x00000000, 0x00000000, 0x00000000
.long 0x00000000, 0x00000000, 0x00000000, 0x00000000, 0x00000000, 0x00000000, 0x00000000, 0x00000000
.long 0x00000000, 0x00000000, 0x00000000, 0x00000000, 0x00000000, 0x00000000, 0x00000000, 0x00000000
.long 0x00000000, 0x00000000, 0x00000000, 0x00000000, 0x00000000, 0x00000000, 0x00000000, 0x00000000
.long 0x00000000, 0x00000000, 0x00000000, 0x00000000, 0x00000000, 0x00000000, 0x00000000, 0x00000000
.long 0x00000000, 0x00000000, 0x00000000, 0x00000000, 0x00000000, 0x00000000, 0x00000000, 0x00000000
.long 0x00000000, 0x00000000, 0x00000000, 0x00000000, 0x00000000, 0x00000000, 0x00000000, 0x00000000
.long 0x00000000, 0x00000000, 0x00000000, 0x00000000, 0x00000000, 0x00000000, 0x00000000, 0x00000000
.long 0x00000000, 0x00000000, 0x00000000, 0x00000000, 0x00000000, 0x00000000, 0x00000000, 0x00000000
.long 0x00000000, 0x00000000, 0x00000000, 0x00000000, 0x00000000, 0x00000000, 0x00000000, 0x00000000
.long 0x00000000, 0x00000000, 0x00000000, 0x00000000, 0x00000000, 0x00000000, 0x00000000, 0x00000000
.long 0x00000000, 0x00000000, 0x00000000, 0x00000000, 0x00000000, 0x00000000, 0x00000000, 0x00000000
.long 0x00000000, 0x00000000, 0x00000000, 0x00000000, 0x00000000, 0x00000000, 0x00000000, 0x00000000
.long 0x00000000, 0x00000000, 0x00000000, 0x00000000, 0x00000000, 0x00000000, 0x00000000, 0x00000000
.long 0x00000000, 0x00000000, 0x00000000, 0x00000000, 0x00000000, 0x00000000, 0x00000000, 0x00000000
.long 0x00000000, 0x00000000, 0x00000000, 0x00000000, 0x00000000, 0x00000000, 0x00000000, 0x00000000
.long 0x00000000, 0x00000000, 0x00000000, 0x00000000, 0x00000000, 0x00000000, 0x00000000, 0x00000000
.long 0x00000000, 0x00000000, 0x00000000, 0x00000000, 0x00000000, 0x00000000, 0x00000000, 0x00000000
.long 0x00000000, 0x00000000, 0x00000000, 0x00000000, 0x00000000, 0x00000000, 0x00000000, 0x00000000
.long 0x00000000, 0x00000000, 0x00000000, 0x00000000, 0x00000000, 0x00000000, 0x00000000, 0x00000000
.long 0x00000000, 0x00000000, 0x00000000, 0x00000000, 0x00000000, 0x00000000, 0x00000000, 0x00000000
.long 0x00000000, 0x00000000, 0x00000000, 0x00000000, 0x00000000, 0x00000000, 0x00000000, 0x00000000
.long 0x00000000, 0x00000000, 0x00000000, 0x00000000, 0x00000000, 0x00000000, 0x00000000, 0x00000000
.long 0x00000000, 0x00000000, 0x00000000, 0x00000000, 0x00000000, 0x00000000, 0x00000000, 0x00000000
.long 0x00000000, 0x00000000, 0x00000000, 0x00000000, 0x00000000, 0x00000000, 0x00000000, 0x00000000
.long 0x00000000, 0x00000000, 0x00000000, 0x00000000, 0x00000000, 0x00000000, 0x00000000, 0x00000000
.long 0x00000000, 0x00000000, 0x00000000, 0x00000000, 0x00000000, 0x00000000, 0x00000000, 0x00000000
.long 0x00000000, 0x00000000, 0x00000000, 0x00000000, 0x00000000, 0x00000000, 0x00000000, 0x00000000
.long 0x00000000, 0x00000000, 0x00000000, 0x00000000, 0x00000000, 0x00000000, 0x00000000, 0x00000000
.long 0x00000000, 0x00000000, 0x00000000, 0x00000000, 0x00000000, 0x00000000, 0x00000000, 0x00000000
.long 0x00000000, 0x00000000, 0x00000000, 0x00000000, 0x00000000, 0x00000000, 0x00000000, 0x00000000
.long 0x00000000, 0x00000000, 0x00000000, 0x00000000, 0x00000000, 0x00000000, 0x00000000, 0x00000000
.long 0x00000000, 0x00000000, 0x00000000, 0x00000000, 0x00000000, 0x00000000, 0x00000000, 0x00000000
.long 0x00000000, 0x00000000, 0x00000000, 0x00000000, 0x00000000, 0x00000000, 0x00000000, 0x00000000
.long 0x00000000, 0x00000000, 0x00000000, 0x00000000, 0x00000000, 0x00000000, 0x00000000, 0x00000000
.long 0x00000000, 0x00000000, 0x00000000, 0x00000000, 0x00000000, 0x00000000, 0x00000000, 0x00000000
.long 0x00000000, 0x00000000, 0x00000000, 0x00000000, 0x00000000, 0x00000000, 0x00000000, 0x00000000
.long 0x00000000, 0x00000000, 0x00000000, 0x00000000, 0x00000000, 0x00000000, 0x00000000, 0x00000000
.long 0x00000000, 0x00000000, 0x00000000, 0x00000000, 0x00000000, 0x00000000, 0x00000000, 0x00000000
.long 0x00000000, 0x00000000, 0x00000000, 0x00000000, 0x00000000, 0x00000000, 0x00000000, 0x00000000
.long 0x00000000, 0x00000000, 0x00000000, 0x00000000, 0x00000000, 0x00000000, 0x00000000, 0x00000000
.long 0x00000000, 0x00000000, 0x00000000, 0x00000000, 0x00000000, 0x00000000, 0x00000000, 0x00000000
.long 0x00000000, 0x00000000, 0x00000000, 0x00000000, 0x00000000, 0x00000000, 0x00000000, 0x00000000
.long 0x00000000, 0x00000000, 0x00000000, 0x00000000, 0x00000000, 0x00000000, 0x00000000, 0x00000000
.long 0x00000000, 0x00000000, 0x00000000, 0x00000000, 0x00000000, 0x00000000, 0x00000000, 0x00000000
.long 0x00000000, 0x00000000, 0x00000000, 0x00000000, 0x00000000, 0x00000000, 0x00000000, 0x00000000
.long 0x00000000, 0x00000000, 0x00000000, 0x00000000, 0x00000000, 0x00000000, 0x00000000, 0x00000000
.long 0x00000000, 0x00000000, 0x00000000, 0x00000000, 0x00000000, 0x00000000, 0x00000000, 0x00000000
.long 0x00000000, 0x00000000, 0x00000000, 0x00000000, 0x00000000, 0x00000000, 0x00000000, 0x00000000
.long 0x00000000, 0x00000000, 0x00000000, 0x00000000, 0x00000000, 0x00000000, 0x00000000, 0x00000000
.long 0x00000000, 0x00000000, 0x00000000, 0x00000000, 0x00000000, 0x00000000, 0x00000000, 0x00000000
.long 0x00000000, 0x00000000, 0x00000000, 0x00000000, 0x00000000, 0x00000000, 0x00000000, 0x00000000
.long 0x00000000, 0x00000000, 0x00000000, 0x00000000, 0x00000000, 0x00000000, 0x00000000, 0x00000000
.long 0x00000000, 0x00000000, 0x00000000, 0x00000000, 0x00000000, 0x00000000, 0x00000000, 0x00000000
.long 0x00000000, 0x00000000, 0x00000000, 0x00000000, 0x00000000, 0x00000000, 0x00000000, 0x00000000
.long 0x00000000, 0x00000000, 0x00000000, 0x00000000, 0x00000000, 0x00000000, 0x00000000, 0x00000000
.long 0x00000000, 0x00000000, 0x00000000, 0x00000000, 0x00000000, 0x00000000, 0x00000000, 0x00000000
.long 0x00000000, 0x00000000, 0x00000000, 0x00000000, 0x00000000, 0x00000000, 0x00000000, 0x00000000
.long 0x00000000, 0x00000000, 0x00000000, 0x00000000, 0x00000000, 0x00000000, 0x00000000, 0x00000000
.long 0x00000000, 0x00000000, 0x00000000, 0x00000000, 0x00000000, 0x00000000, 0x00000000, 0x00000000
.long 0x00000000, 0x00000000, 0x00000000, 0x00000000, 0x00000000, 0x00000000, 0x00000000, 0x00000000
.long 0x00000000, 0x00000000, 0x00000000, 0x00000000, 0x00000000, 0x00000000, 0x00000000, 0x00000000
.long 0x00000000, 0x00000000, 0x00000000, 0x00000000, 0x00000000, 0x00000000, 0x00000000, 0x00000000
.long 0x00000000, 0x00000000, 0x00000000, 0x00000000, 0x00000000, 0x00000000, 0x00000000, 0x00000000
.long 0x00000000, 0x00000000, 0x00000000, 0x00000000, 0x00000000, 0x00000000, 0x00000000, 0x00000000
.long 0x00000000, 0x00000000, 0x00000000, 0x00000000, 0x00000000, 0x00000000, 0x00000000, 0x00000000
.long 0x00000000, 0x00000000, 0x00000000, 0x00000000, 0x00000000, 0x00000000, 0x00000000, 0x00000000
.long 0x00000000, 0x00000000, 0x00000000, 0x00000000, 0x00000000, 0x00000000, 0x00000000, 0x00000000
.long 0x00000000, 0x00000000, 0x00000000, 0x00000000, 0x00000000, 0x00000000, 0x00000000, 0x00000000
.long 0x00000000, 0x00000000, 0x00000000, 0x00000000, 0x00000000, 0x00000000, 0x00000000, 0x00000000
.long 0x00000000, 0x00000000, 0x00000000, 0x00000000, 0x00000000, 0x00000000, 0x00000000, 0x00000000
.long 0x00000000, 0x00000000, 0x00000000, 0x00000000, 0x00000000, 0x00000000, 0x00000000, 0x00000000
.long 0x00000000, 0x00000000, 0x00000000, 0x00000000, 0x00000000, 0x00000000, 0x00000000, 0x00000000
.long 0x00000000, 0x00000000, 0x00000000, 0x00000000, 0x00000000, 0x00000000, 0x00000000, 0x00000000
.long 0x00000000, 0x00000000, 0x00000000, 0x00000000, 0x00000000, 0x00000000, 0x00000000, 0x00000000
.long 0x00000000, 0x00000000, 0x00000000, 0x00000000, 0x00000000, 0x00000000, 0x00000000, 0x00000000
.long 0x00000000, 0x00000000, 0x00000000, 0x00000000, 0x00000000, 0x00000000, 0x00000000, 0x00000000
.long 0x00000000, 0x00000000, 0x00000000, 0x00000000, 0x00000000, 0x00000000, 0x00000000, 0x00000000
.long 0x00000000, 0x00000000, 0x00000000, 0x00000000, 0x00000000, 0x00000000, 0x00000000, 0x00000000
.long 0x00000000, 0x00000000, 0x00000000, 0x00000000, 0x00000000, 0x00000000, 0x00000000, 0x00000000
.long 0x00000000, 0x00000000, 0x00000000, 0x00000000, 0x00000000, 0x00000000, 0x00000000, 0x00000000
.long 0x00000000, 0x00000000, 0x00000000, 0x00000000, 0x00000000, 0x00000000, 0x00000000, 0x00000000
.long 0x00000000, 0x00000000, 0x00000000, 0x00000000, 0x00000000, 0x00000000, 0x00000000, 0x00000000
.long 0x00000000, 0x00000000, 0x00000000, 0x00000000, 0x00000000, 0x00000000, 0x00000000, 0x00000000
.long 0x00000000, 0x00000000, 0x00000000, 0x00000000, 0x00000000, 0x00000000, 0x00000000, 0x00000000
.long 0x00000000, 0x00000000, 0x00000000, 0x00000000, 0x00000000, 0x00000000, 0x00000000, 0x00000000
.long 0x00000000, 0x00000000, 0x00000000, 0x00000000, 0x00000000, 0x00000000, 0x00000000, 0x00000000
.long 0x00000000, 0x00000000, 0x00000000, 0x00000000, 0x00000000, 0x00000000, 0x00000000, 0x00000000
.long 0x00000000, 0x00000000, 0x00000000, 0x00000000, 0x00000000, 0x00000000, 0x00000000, 0x00000000
.long 0x00000000, 0x00000000, 0x00000000, 0x00000000, 0x00000000, 0x00000000, 0x00000000, 0x00000000
.long 0x00000000, 0x00000000, 0x00000000, 0x00000000, 0x00000000, 0x00000000, 0x00000000, 0x00000000
.long 0x00000000, 0x00000000, 0x00000000, 0x00000000, 0x00000000, 0x00000000, 0x00000000, 0x00000000
.long 0x00000000, 0x00000000, 0x00000000, 0x00000000, 0x00000000, 0x00000000, 0x00000000, 0x00000000
.long 0x00000000, 0x00000000, 0x00000000, 0x00000000, 0x00000000, 0x00000000, 0x00000000, 0x00000000
.long 0x00000000, 0x00000000, 0x00000000, 0x00000000, 0x00000000, 0x00000000, 0x00000000, 0x00000000
.long 0x00000000, 0x00000000, 0x00000000, 0x00000000, 0x00000000, 0x00000000, 0x00000000, 0x00000000
.long 0x00000000, 0x00000000, 0x00000000, 0x00000000, 0x00000000, 0x00000000, 0x00000000, 0x00000000
.long 0x00000000, 0x00000000, 0x00000000, 0x00000000, 0x00000000, 0x00000000, 0x00000000, 0x00000000
.long 0x00000000, 0x00000000, 0x00000000, 0x00000000, 0x00000000, 0x00000000, 0x00000000, 0x00000000
.long 0x00000000, 0x00000000, 0x00000000, 0x00000000, 0x00000000, 0x00000000, 0x00000000, 0x00000000
.long 0x00000000, 0x00000000, 0x00000000, 0x00000000, 0x00000000, 0x00000000, 0x00000000, 0x00000000
.long 0x00000000, 0x00000000, 0x00000000, 0x00000000, 0x00000000, 0x00000000, 0x00000000, 0x00000000
.long 0x00000000, 0x00000000, 0x00000000, 0x00000000, 0x00000000, 0x00000000, 0x00000000, 0x00000000
.long 0x00000000, 0x00000000, 0x00000000, 0x00000000, 0x00000000, 0x00000000, 0x00000000, 0x00000000
.long 0x00000000, 0x00000000, 0x00000000, 0x00000000, 0x00000000, 0x00000000, 0x00000000, 0x00000000
.long 0x00000000, 0x00000000, 0x00000000, 0x00000000, 0x00000000, 0x00000000, 0x00000000, 0x00000000
.long 0x00000000, 0x00000000, 0x00000000, 0x00000000, 0x00000000, 0x00000000, 0x00000000, 0x00000000
.long 0x00000000, 0x00000000, 0x00000000, 0x00000000, 0x00000000, 0x00000000, 0x00000000, 0x00000000
.long 0x00000000, 0x00000000, 0x00000000, 0x00000000, 0x00000000, 0x00000000, 0x00000000, 0x00000000
.long 0x00000000, 0x00000000, 0x00000000, 0x00000000, 0x00000000, 0x00000000, 0x00000000, 0x00000000
.long 0x00000000, 0x00000000, 0x00000000, 0x00000000, 0x00000000, 0x00000000, 0x00000000, 0x00000000
.long 0x00000000, 0x00000000, 0x00000000, 0x00000000, 0x00000000, 0x00000000, 0x00000000, 0x00000000
.long 0x00000000, 0x00000000, 0x00000000, 0x00000000, 0x00000000, 0x00000000, 0x00000000, 0x00000000
.long 0x00000000, 0x00000000, 0x00000000, 0x00000000, 0x00000000, 0x00000000, 0x00000000, 0x00000000
.long 0x00000000, 0x00000000, 0x00000000, 0x00000000, 0x00000000, 0x00000000, 0x00000000, 0x00000000
.long 0x00000000, 0x00000000, 0x00000000, 0x00000000, 0x00000000, 0x00000000, 0x00000000, 0x00000000
.long 0x00000000, 0x00000000, 0x00000000, 0x00000000, 0x00000000, 0x00000000, 0x00000000, 0x00000000
.long 0x00000000, 0x00000000, 0x00000000, 0x00000000, 0x00000000, 0x00000000, 0x00000000, 0x00000000
.long 0x00000000, 0x00000000, 0x00000000, 0x00000000, 0x00000000, 0x00000000, 0x00000000, 0x00000000
.long 0x00000000, 0x00000000, 0x00000000, 0x00000000, 0x00000000, 0x00000000, 0x00000000, 0x00000000
.long 0x00000000, 0x00000000, 0x00000000, 0x00000000, 0x00000000, 0x00000000, 0x00000000, 0x00000000
.long 0x00000000, 0x00000000, 0x00000000, 0x00000000, 0x00000000, 0x00000000, 0x00000000, 0x00000000
.long 0x00000000, 0x00000000, 0x00000000, 0x00000000, 0x00000000, 0x00000000, 0x00000000, 0x00000000
.long 0x00000000, 0x00000000, 0x00000000, 0x00000000, 0x00000000, 0x00000000, 0x00000000, 0x00000000
.long 0x00000000, 0x00000000, 0x00000000, 0x00000000, 0x00000000, 0x00000000, 0x00000000, 0x00000000
.long 0x00000000, 0x00000000, 0x00000000, 0x00000000, 0x00000000, 0x00000000, 0x00000000, 0x00000000
.long 0x00000000, 0x00000000, 0x00000000, 0x00000000, 0x00000000, 0x00000000, 0x00000000, 0x00000000
.long 0x00000000, 0x00000000, 0x00000000, 0x00000000, 0x00000000, 0x00000000, 0x00000000, 0x00000000
.long 0x00000000, 0x00000000, 0x00000000, 0x00000000, 0x00000000, 0x00000000, 0x00000000, 0x00000000
.long 0x00000000, 0x00000000, 0x00000000, 0x00000000, 0x00000000, 0x00000000, 0x00000000, 0x00000000
.long 0x00000000, 0x00000000, 0x00000000, 0x00000000, 0x00000000, 0x00000000, 0x00000000, 0x00000000
.long 0x00000000, 0x00000000, 0x00000000, 0x00000000, 0x00000000, 0x00000000, 0x00000000, 0x00000000
.long 0x00000000, 0x00000000, 0x00000000, 0x00000000, 0x00000000, 0x00000000, 0x00000000, 0x00000000
.long 0x00000000, 0x00000000, 0x00000000, 0x00000000, 0x00000000, 0x00000000, 0x00000000, 0x00000000
.long 0x00000000, 0x00000000, 0x00000000, 0x00000000, 0x00000000, 0x00000000, 0x00000000, 0x00000000
.long 0x00000000, 0x00000000, 0x00000000, 0x00000000, 0x00000000, 0x00000000, 0x00000000, 0x00000000
.long 0x00000000, 0x00000000, 0x00000000, 0x00000000, 0x00000000, 0x00000000, 0x00000000, 0x00000000
.long 0x00000000, 0x00000000, 0x00000000, 0x00000000, 0x00000000, 0x00000000, 0x00000000, 0x00000000
.long 0x00000000, 0x00000000, 0x00000000, 0x00000000, 0x00000000, 0x00000000, 0x00000000, 0x00000000
.long 0x00000000, 0x00000000, 0x00000000, 0x00000000, 0x00000000, 0x00000000, 0x00000000, 0x00000000
.long 0x00000000, 0x00000000, 0x00000000, 0x00000000, 0x00000000, 0x00000000, 0x00000000, 0x00000000
.long 0x00000000, 0x00000000, 0x00000000, 0x00000000, 0x00000000, 0x00000000, 0x00000000, 0x00000000
.long 0x00000000, 0x00000000, 0x00000000, 0x00000000, 0x00000000, 0x00000000, 0x00000000, 0x00000000
.long 0x00000000, 0x00000000, 0x00000000, 0x00000000, 0x00000000, 0x00000000, 0x00000000, 0x00000000
.long 0x00000000, 0x00000000, 0x00000000, 0x00000000, 0x00000000, 0x00000000, 0x00000000, 0x00000000
.long 0x00000000, 0x00000000, 0x00000000, 0x00000000, 0x00000000, 0x00000000, 0x00000000, 0x00000000
.long 0x00000000, 0x00000000, 0x00000000, 0x00000000, 0x00000000, 0x00000000, 0x00000000, 0x00000000
.long 0x00000000, 0x00000000, 0x00000000, 0x00000000, 0x00000000, 0x00000000, 0x00000000, 0x00000000
.long 0x00000000, 0x00000000, 0x00000000, 0x00000000, 0x00000000, 0x00000000, 0x00000000, 0x00000000
.long 0x00000000, 0x00000000, 0x00000000, 0x00000000, 0x00000000, 0x00000000, 0x00000000, 0x00000000
.long 0x00000000, 0x00000000, 0x00000000, 0x00000000, 0x00000000, 0x00000000, 0x00000000, 0x00000000
.long 0x00000000, 0x00000000, 0x00000000, 0x00000000, 0x00000000, 0x00000000, 0x00000000, 0x00000000
.long 0x00000000, 0x00000000, 0x00000000, 0x00000000, 0x00000000, 0x00000000, 0x00000000, 0x00000000
.long 0x00000000, 0x00000000, 0x00000000, 0x00000000, 0x00000000, 0x00000000, 0x00000000, 0x00000000
.long 0x00000000, 0x00000000, 0x00000000, 0x00000000, 0x00000000, 0x00000000, 0x00000000, 0x00000000
.long 0x00000000, 0x00000000, 0x00000000, 0x00000000, 0x00000000, 0x00000000, 0x00000000, 0x00000000
.long 0x00000000, 0x00000000, 0x00000000, 0x00000000, 0x00000000, 0x00000000, 0x00000000, 0x00000000
.long 0x00000000, 0x00000000, 0x00000000, 0x00000000, 0x00000000, 0x00000000, 0x00000000, 0x00000000
.long 0x00000000, 0x00000000, 0x00000000, 0x00000000, 0x00000000, 0x00000000, 0x00000000, 0x00000000
.long 0x00000000, 0x00000000, 0x00000000, 0x00000000, 0x00000000, 0x00000000, 0x00000000, 0x00000000
.long 0x00000000, 0x00000000, 0x00000000, 0x00000000, 0x00000000, 0x00000000, 0x00000000, 0x00000000
.size gather_tab, 12288
.section .rodata,"a"
.p2align 6
.amdhsa_kernel concat_heads__ssm_conv_s4d__linear_attn_block__prompt_kernel
  .amdhsa_next_free_vgpr 256
  .amdhsa_next_free_sgpr 102
  .amdhsa_accum_offset 256
  .amdhsa_group_segment_fixed_size 0
  .amdhsa_kernarg_size 104
  .amdhsa_user_sgpr_count 2
  .amdhsa_user_sgpr_kernarg_segment_ptr 1
  .amdhsa_system_sgpr_workgroup_id_x 1
.end_amdhsa_kernel
```
